```python
import torch

def _softmax(x, axis=-1):
    return torch.softmax(x, dim=axis)
def _gelu(x):
    return torch.nn.functional.gelu(x, approximate="tanh")
def _silu(x):
    return torch.nn.functional.silu(x)
def _sigmoid(x):
    return torch.sigmoid(x)
def _layernorm(x, axis=-1, eps=1e-5):
    m = x.mean(dim=axis, keepdim=True)
    v = x.var(dim=axis, keepdim=True, unbiased=False)
    return (x - m) / torch.sqrt(v + eps)
def _scatter_add(tgt, idx, src, axis=0):
    return tgt.clone().index_add_(axis, idx, src)
def _segment_sum(src, seg, n):
    out = torch.zeros((n,) + src.shape[1:], dtype=src.dtype)
    return out.index_add_(0, seg, src)
def _pad(x, pw):
    flat = tuple(v for pair in reversed(pw) for v in pair)
    return torch.nn.functional.pad(x, flat)

kernel_name = 'standalone__detection_seg_dino__vision'

def setup_inputs():

    _w = (lambda a: (lambda t: t.to(torch.bfloat16) if t.is_floating_point() else t)(torch.as_tensor(a)))
    H = W = (384 // 2) * 2
    C = 96
    Nq = 16
    sc = C ** -0.5
    return {
        "q": _w((lambda *s: torch.randn(*s, dtype=torch.bfloat16) * 0.05)(1, Nq, C)),
        "f0": _w((lambda *s: torch.randn(*s, dtype=torch.bfloat16) * 0.8)(1, H, W, C)),
        "f1": _w((lambda *s: torch.randn(*s, dtype=torch.bfloat16) * 0.8)(1, H // 2, W // 2, C)),
        "wq": _w((lambda *s: torch.randn(*s, dtype=torch.bfloat16) * 3.2)(C, C) * sc),
        "wk": _w((lambda *s: torch.randn(*s, dtype=torch.bfloat16) * 3.2)(C, C) * sc),
        "wv": _w((lambda *s: torch.randn(*s, dtype=torch.bfloat16) * 0.8)(C, C) * sc),
        "wo": _w((lambda *s: torch.randn(*s, dtype=torch.bfloat16) * 0.8)(C, C) * sc),
    }

def reference(q, f0, f1, wq, wk, wv, wo):
    B, H, W, C = f0.shape
    f1u = (lambda x, n, axis: torch.repeat_interleave(x, n, dim=axis))((lambda x, n, axis: torch.repeat_interleave(x, n, dim=axis))(f1, 2, axis=1), 2, axis=2)
    fused = f0 + f1u
    feats = _layernorm(fused.reshape(B, H * W, C), axis=-1)
    qn = _layernorm(q, axis=-1)
    Q = torch.einsum("bnc,cd->bnd", qn, wq)
    K = torch.einsum("bmc,cd->bmd", feats, wk)
    V = torch.einsum("bmc,cd->bmd", feats, wv)
    scale = C ** -0.5
    logits = torch.einsum("bnd,bmd->bnm", Q, K) * scale
    attn = _softmax(logits, axis=-1)
    ctx = torch.einsum("bnm,bmd->bnd", attn, V)
    return q + torch.einsum("bnd,dc->bnc", ctx, wo)
```

```asm
; @launch grid=(256,1,1) block=(768,1,1) lds=163840
.amdgcn_target "amdgcn-amd-amdhsa--gfx950"
.text
.set CODE_LEN, L_end - standalone__detection_seg_dino__vision_kernel - 256
.p2align 12
.globl standalone__detection_seg_dino__vision_kernel
.p2align 8
.type standalone__detection_seg_dino__vision_kernel,@function
standalone__detection_seg_dino__vision_kernel:
    s_cmp_ge_u32 s2, 256
    s_cbranch_scc1 L_end
    s_load_dwordx16 s[16:31], s[0:1], 0
    s_load_dwordx4 s[32:35], s[0:1], 64
    s_getpc_b64 s[6:7]
    v_lshlrev_b32 v6, 7, v0
    v_min_u32 v6, CODE_LEN, v6
    v_cmp_gt_u32 vcc, 128, v0
    s_nop 0
    s_and_saveexec_b64 s[8:9], vcc
    s_cbranch_execz L_nopf
    global_load_dword v51, v6, s[6:7]
L_nopf:
    s_mov_b64 exec, s[8:9]
    v_and_b32 v1, 63, v0
    v_lshrrev_b32 v6, 6, v0
    v_and_b32 v2, 15, v1
    v_readfirstlane_b32 s3, v6
    v_lshrrev_b32 v3, 4, v1
    v_lshlrev_b32 v4, 4, v1
    v_mov_b32 v5, 0
    s_mov_b32 s82, 0
    s_mov_b32 s6, 0x3210ba98
    s_mov_b32 s7, 0x7edc
    s_lshl_b32 s70, s3, 2
    s_lshr_b64 s[6:7], s[6:7], s70
    s_and_b32 s4, s6, 15
    s_cmp_eq_u32 s3, 3
    s_cbranch_scc1 L_loader
    s_cmp_gt_u32 s3, 3
    s_cbranch_scc1 L_other
    s_setprio 3
    s_sub_u32 s4, s4, 8
    v_mul_u32_u24 v10, 192, v2
    v_lshl_add_u32 v10, v3, 4, v10
    v_lshrrev_b32 v6, 2, v1
    v_and_b32 v7, 3, v1
    v_mul_u32_u24 v11, 192, v6
    v_lshl_add_u32 v11, v7, 4, v11
    s_mul_i32 s72, s4, 6144
    s_lshl_b32 s70, s4, 6
    s_add_u32 s72, s72, 145408
    s_lshl_b32 s71, s4, 10
    s_mov_b32 m0, s71
    s_waitcnt lgkmcnt(0)
    s_mov_b32 s44, s16
    s_and_b32 s45, s17, 0xffff
    s_mov_b32 s46, 3072
    s_mov_b32 s47, 0x00020000
    buffer_load_dwordx4 v4, s[44:47], s71 offen lds
    s_mov_b32 m0, s72
    s_mov_b32 s48, s22
    s_and_b32 s49, s23, 0xffff
    s_mov_b32 s50, 18432
    s_mov_b32 s51, 0x00020000
    buffer_load_dwordx4 v11, s[48:51], s70 offen lds
    s_add_u32 m0, s72, 1024
    s_add_u32 s70, s70, 3072
    buffer_load_dwordx4 v11, s[48:51], s70 offen lds
    s_add_u32 m0, s72, 2048
    s_add_u32 s70, s70, 3072
    buffer_load_dwordx4 v11, s[48:51], s70 offen lds
    s_add_u32 m0, s72, 3072
    s_add_u32 s70, s70, 3072
    buffer_load_dwordx4 v11, s[48:51], s70 offen lds
    s_add_u32 m0, s72, 4096
    s_add_u32 s70, s70, 3072
    buffer_load_dwordx4 v11, s[48:51], s70 offen lds
    s_add_u32 m0, s72, 5120
    s_add_u32 s70, s70, 3072
    buffer_load_dwordx4 v11, s[48:51], s70 offen lds
    s_barrier
    s_branch L_helper
L_other:
    v_lshlrev_b32 v6, 2, v1
    ds_write_b32 v6, v5 offset:6656
    s_sub_u32 s70, s3, 4
    s_branch L_padgo
L_padret:
    s_cmp_ge_u32 s70, 8
    s_cbranch_scc1 L_padnb
    s_waitcnt lgkmcnt(0)
    s_barrier
L_padnb:
    s_add_u32 s70, s70, 8
L_padgo:
    s_cmp_eq_u32 s70, 0
    s_cbranch_scc1 L_pad0
    s_cmp_eq_u32 s70, 1
    s_cbranch_scc1 L_pad1
    s_cmp_eq_u32 s70, 2
    s_cbranch_scc1 L_pad2
    s_cmp_eq_u32 s70, 3
    s_cbranch_scc1 L_pad3
    s_cmp_eq_u32 s70, 4
    s_cbranch_scc1 L_pad4
    s_cmp_eq_u32 s70, 5
    s_cbranch_scc1 L_pad5
    s_cmp_eq_u32 s70, 6
    s_cbranch_scc1 L_pad6
    s_cmp_eq_u32 s70, 7
    s_cbranch_scc1 L_pad7
    s_cmp_eq_u32 s70, 8
    s_cbranch_scc1 L_pad8
    s_cmp_eq_u32 s70, 9
    s_cbranch_scc1 L_pad9
    s_cmp_eq_u32 s70, 10
    s_cbranch_scc1 L_pad10
    s_cmp_eq_u32 s70, 11
    s_cbranch_scc1 L_pad11
    s_cmp_eq_u32 s70, 12
    s_cbranch_scc1 L_pad12
    s_cmp_eq_u32 s70, 13
    s_cbranch_scc1 L_pad13
    s_cmp_eq_u32 s70, 14
    s_cbranch_scc1 L_pad14
    s_cmp_eq_u32 s70, 15
    s_cbranch_scc1 L_pad15
    s_cmp_eq_u32 s70, 16
    s_cbranch_scc1 L_pad16
    s_cmp_eq_u32 s70, 17
    s_cbranch_scc1 L_pad17
    s_cmp_eq_u32 s70, 18
    s_cbranch_scc1 L_pad18
    s_cmp_eq_u32 s70, 19
    s_cbranch_scc1 L_pad19
    s_cmp_lt_u32 s4, 8
    s_cbranch_scc1 L_comp
    s_branch L_finisher
L_pad17:
    s_branch L_padret
L_loader:
    s_setprio 3
    v_xor_b32 v6, 32, v4
    v_cmp_lt_u32 vcc, 47, v1
    s_mul_i32 s73, s2, 18
    s_mul_i32 s69, s2, 27648
    v_cndmask_b32 v10, v4, v6, vcc
    v_cmp_gt_u32 vcc, 32, v1
    s_mul_hi_u32 s70, s73, 0xaaaaaab
    s_mul_i32 s71, s70, 24
    v_cndmask_b32 v11, v4, v6, vcc
    v_cmp_lt_u32 vcc, 15, v1
    s_sub_u32 s73, s73, s71
    s_mul_i32 s67, s70, 147456
    v_cndmask_b32 v12, v4, v6, vcc
    s_mul_i32 s71, s73, 3072
    s_add_u32 s67, s67, s71
    s_add_u32 s72, s67, 73728
    v_mov_b32 v13, 1
    s_waitcnt lgkmcnt(0)
    s_mov_b32 s40, s20
    s_and_b32 s41, s21, 0xffff
    s_mov_b32 s42, 7077888
    s_mov_b32 s43, 0x00020000
    s_mov_b32 s36, s18
    s_and_b32 s37, s19, 0xffff
    s_mov_b32 s38, 28311552
    s_mov_b32 s39, 0x00020000
    s_mov_b32 m0, 25600
    s_nop 0
    buffer_load_dwordx4 v4, s[40:43], s69 offen offset:0 nt lds
    buffer_load_dwordx4 v4, s[40:43], s69 offen offset:1024 nt lds
    buffer_load_dwordx4 v4, s[40:43], s69 offen offset:2048 nt lds
    s_cmp_ge_u32 s73, 24
    s_cselect_b32 s68, s72, s67
    s_mov_b32 m0, 53248
    s_add_u32 s68, s68, 0
    buffer_load_dwordx4 v10, s[36:39], s68 offen offset:0 nt lds
    buffer_load_dwordx4 v11, s[36:39], s68 offen offset:1024 nt lds
    buffer_load_dwordx4 v12, s[36:39], s68 offen offset:2048 nt lds
    s_cmp_ge_u32 s73, 24
    s_cselect_b32 s68, s72, s67
    s_mov_b32 m0, 56320
    s_add_u32 s68, s68, 73728
    buffer_load_dwordx4 v10, s[36:39], s68 offen offset:0 nt lds
    buffer_load_dwordx4 v11, s[36:39], s68 offen offset:1024 nt lds
    buffer_load_dwordx4 v12, s[36:39], s68 offen offset:2048 nt lds
    s_mov_b32 m0, 28672
    s_add_u32 s69, s69, 3072
    buffer_load_dwordx4 v4, s[40:43], s69 offen offset:0 nt lds
    buffer_load_dwordx4 v4, s[40:43], s69 offen offset:1024 nt lds
    buffer_load_dwordx4 v4, s[40:43], s69 offen offset:2048 nt lds
    s_cmp_ge_u32 s73, 23
    s_cselect_b32 s68, s72, s67
    s_mov_b32 m0, 59392
    s_add_u32 s68, s68, 3072
    buffer_load_dwordx4 v10, s[36:39], s68 offen offset:0 nt lds
    buffer_load_dwordx4 v11, s[36:39], s68 offen offset:1024 nt lds
    buffer_load_dwordx4 v12, s[36:39], s68 offen offset:2048 nt lds
    s_cmp_ge_u32 s73, 23
    s_cselect_b32 s68, s72, s67
    s_mov_b32 m0, 62464
    s_add_u32 s68, s68, 76800
    buffer_load_dwordx4 v10, s[36:39], s68 offen offset:0 nt lds
    buffer_load_dwordx4 v11, s[36:39], s68 offen offset:1024 nt lds
    buffer_load_dwordx4 v12, s[36:39], s68 offen offset:2048 nt lds
    s_mov_b32 m0, 31744
    s_add_u32 s69, s69, 3072
    buffer_load_dwordx4 v4, s[40:43], s69 offen offset:0 nt lds
    buffer_load_dwordx4 v4, s[40:43], s69 offen offset:1024 nt lds
    buffer_load_dwordx4 v4, s[40:43], s69 offen offset:2048 nt lds
    s_barrier
    s_mov_b32 s48, s24
    s_and_b32 s49, s25, 0xffff
    s_mov_b32 s50, 18432
    s_mov_b32 s51, 0x00020000
    s_mov_b32 s52, s26
    s_and_b32 s53, s27, 0xffff
    s_mov_b32 s54, 18432
    s_mov_b32 s55, 0x00020000
    s_mov_b32 s44, s28
    s_and_b32 s45, s29, 0xffff
    s_mov_b32 s46, 18432
    s_mov_b32 s47, 0x00020000
    s_mov_b32 s56, s34
    s_and_b32 s57, s35, 0xffff
    s_mov_b32 s58, 268435456
    s_mov_b32 s59, 0x00020000
    s_and_b32 s83, s2, 7
    s_lshl_b32 s83, s83, 5
    s_lshr_b32 s71, s2, 3
    s_add_u32 s83, s83, s71
    s_lshl_b32 s83, s83, 6
    s_add_u32 s81, s83, 1048576
    v_lshlrev_b32 v14, 14, v1
    s_cmp_ge_u32 s73, 22
    s_cselect_b32 s68, s72, s67
    s_mov_b32 m0, 65536
    s_add_u32 s68, s68, 6144
    buffer_load_dwordx4 v10, s[36:39], s68 offen offset:0 nt lds
    buffer_load_dwordx4 v11, s[36:39], s68 offen offset:1024 nt lds
    buffer_load_dwordx4 v12, s[36:39], s68 offen offset:2048 nt lds
    s_cmp_ge_u32 s73, 21
    s_cselect_b32 s68, s72, s67
    s_mov_b32 m0, 68608
    s_add_u32 s68, s68, 9216
    buffer_load_dwordx4 v10, s[36:39], s68 offen offset:0 nt lds
    buffer_load_dwordx4 v11, s[36:39], s68 offen offset:1024 nt lds
    buffer_load_dwordx4 v12, s[36:39], s68 offen offset:2048 nt lds
    s_mov_b32 m0, 126976
    s_movk_i32 s70, 0
    buffer_load_dwordx4 v10, s[48:51], s70 offen offset:0 lds
    buffer_load_dwordx4 v11, s[48:51], s70 offen offset:1024 lds
    buffer_load_dwordx4 v12, s[48:51], s70 offen offset:2048 lds
    s_mov_b32 m0, 130048
    s_movk_i32 s70, 3072
    buffer_load_dwordx4 v10, s[48:51], s70 offen offset:0 lds
    buffer_load_dwordx4 v11, s[48:51], s70 offen offset:1024 lds
    buffer_load_dwordx4 v12, s[48:51], s70 offen offset:2048 lds
    s_mov_b32 m0, 133120
    s_movk_i32 s70, 6144
    buffer_load_dwordx4 v10, s[48:51], s70 offen offset:0 lds
    buffer_load_dwordx4 v11, s[48:51], s70 offen offset:1024 lds
    buffer_load_dwordx4 v12, s[48:51], s70 offen offset:2048 lds
    s_mov_b32 m0, 136192
    s_movk_i32 s70, 9216
    buffer_load_dwordx4 v10, s[48:51], s70 offen offset:0 lds
    buffer_load_dwordx4 v11, s[48:51], s70 offen offset:1024 lds
    buffer_load_dwordx4 v12, s[48:51], s70 offen offset:2048 lds
    s_mov_b32 m0, 139264
    s_movk_i32 s70, 12288
    buffer_load_dwordx4 v10, s[48:51], s70 offen offset:0 lds
    buffer_load_dwordx4 v11, s[48:51], s70 offen offset:1024 lds
    buffer_load_dwordx4 v12, s[48:51], s70 offen offset:2048 lds
    s_waitcnt vmcnt(36)
    s_branch L_pads1
L_pad6:
    s_branch L_padret
L_pads1:
    ds_write_b32 v5, v13 offset:6752
    v_add_u32 v13, 1, v13
    s_mov_b32 m0, 142336
    s_movk_i32 s70, 15360
    buffer_load_dwordx4 v10, s[48:51], s70 offen offset:0 lds
    buffer_load_dwordx4 v11, s[48:51], s70 offen offset:1024 lds
    buffer_load_dwordx4 v12, s[48:51], s70 offen offset:2048 lds
    s_waitcnt vmcnt(36)
    ds_write_b32 v5, v13 offset:6752
    v_add_u32 v13, 1, v13
    s_mov_b32 m0, 34816
    s_add_u32 s69, s69, 3072
    buffer_load_dwordx4 v4, s[40:43], s69 offen offset:0 nt lds
    buffer_load_dwordx4 v4, s[40:43], s69 offen offset:1024 nt lds
    buffer_load_dwordx4 v4, s[40:43], s69 offen offset:2048 nt lds
    s_cmp_ge_u32 s73, 20
    s_cselect_b32 s68, s72, s67
    s_mov_b32 m0, 71680
    s_add_u32 s68, s68, 12288
    buffer_load_dwordx4 v10, s[36:39], s68 offen offset:0 nt lds
    buffer_load_dwordx4 v11, s[36:39], s68 offen offset:1024 nt lds
    buffer_load_dwordx4 v12, s[36:39], s68 offen offset:2048 nt lds
    s_waitcnt vmcnt(36)
    ds_write_b32 v5, v13 offset:6752
    v_add_u32 v13, 1, v13
    s_cmp_ge_u32 s73, 19
    s_cselect_b32 s68, s72, s67
    s_mov_b32 m0, 74752
    s_add_u32 s68, s68, 15360
    buffer_load_dwordx4 v10, s[36:39], s68 offen offset:0 nt lds
    buffer_load_dwordx4 v11, s[36:39], s68 offen offset:1024 nt lds
    buffer_load_dwordx4 v12, s[36:39], s68 offen offset:2048 nt lds
    s_waitcnt vmcnt(36)
    ds_write_b32 v5, v13 offset:6752
    v_add_u32 v13, 1, v13
    s_mov_b32 m0, 37888
    s_add_u32 s69, s69, 3072
    buffer_load_dwordx4 v4, s[40:43], s69 offen offset:0 nt lds
    buffer_load_dwordx4 v4, s[40:43], s69 offen offset:1024 nt lds
    buffer_load_dwordx4 v4, s[40:43], s69 offen offset:2048 nt lds
    s_cmp_ge_u32 s73, 18
    s_cselect_b32 s68, s72, s67
    s_mov_b32 m0, 77824
    s_add_u32 s68, s68, 18432
    buffer_load_dwordx4 v10, s[36:39], s68 offen offset:0 nt lds
    buffer_load_dwordx4 v11, s[36:39], s68 offen offset:1024 nt lds
    buffer_load_dwordx4 v12, s[36:39], s68 offen offset:2048 nt lds
    s_waitcnt vmcnt(36)
    ds_write_b32 v5, v13 offset:6752
    v_add_u32 v13, 1, v13
L_w1:
    ds_read_b128 v[16:19], v5 offset:6656
    s_add_u32 s82, s82, 1
    s_cmp_gt_u32 s82, 4194304
    s_cbranch_scc1 L_end
    s_waitcnt lgkmcnt(0)
    v_min3_u32 v16, v16, v17, v18
    v_cmp_eq_u32 vcc, 0, v16
    s_cbranch_vccnz L_w1
    s_mov_b32 m0, 145408
    s_movk_i32 s70, 0
    buffer_load_dwordx4 v4, s[44:47], s70 offen offset:0 lds
    buffer_load_dwordx4 v4, s[44:47], s70 offen offset:1024 lds
    buffer_load_dwordx4 v4, s[44:47], s70 offen offset:2048 lds
    s_waitcnt vmcnt(36)
    ds_write_b32 v5, v13 offset:6752
    v_add_u32 v13, 1, v13
    s_cmp_ge_u32 s73, 17
    s_cselect_b32 s68, s72, s67
    s_mov_b32 m0, 80896
    s_add_u32 s68, s68, 21504
    buffer_load_dwordx4 v10, s[36:39], s68 offen offset:0 nt lds
    buffer_load_dwordx4 v11, s[36:39], s68 offen offset:1024 nt lds
    buffer_load_dwordx4 v12, s[36:39], s68 offen offset:2048 nt lds
    s_mov_b32 m0, 148480
    s_movk_i32 s70, 3072
    buffer_load_dwordx4 v4, s[44:47], s70 offen offset:0 lds
    buffer_load_dwordx4 v4, s[44:47], s70 offen offset:1024 lds
    buffer_load_dwordx4 v4, s[44:47], s70 offen offset:2048 lds
    s_mov_b32 m0, 40960
    s_add_u32 s69, s69, 3072
    buffer_load_dwordx4 v4, s[40:43], s69 offen offset:0 nt lds
    buffer_load_dwordx4 v4, s[40:43], s69 offen offset:1024 nt lds
    buffer_load_dwordx4 v4, s[40:43], s69 offen offset:2048 nt lds
    s_mov_b32 m0, 151552
    s_movk_i32 s70, 6144
    buffer_load_dwordx4 v4, s[44:47], s70 offen offset:0 lds
    buffer_load_dwordx4 v4, s[44:47], s70 offen offset:1024 lds
    buffer_load_dwordx4 v4, s[44:47], s70 offen offset:2048 lds
    s_cmp_ge_u32 s73, 16
    s_cselect_b32 s68, s72, s67
    s_mov_b32 m0, 83968
    s_add_u32 s68, s68, 24576
    buffer_load_dwordx4 v10, s[36:39], s68 offen offset:0 nt lds
    buffer_load_dwordx4 v11, s[36:39], s68 offen offset:1024 nt lds
    buffer_load_dwordx4 v12, s[36:39], s68 offen offset:2048 nt lds
    s_mov_b32 m0, 154624
    s_movk_i32 s70, 9216
    buffer_load_dwordx4 v4, s[44:47], s70 offen offset:0 lds
    buffer_load_dwordx4 v4, s[44:47], s70 offen offset:1024 lds
    buffer_load_dwordx4 v4, s[44:47], s70 offen offset:2048 lds
    s_waitcnt vmcnt(36)
    ds_write_b32 v5, v13 offset:6760
    s_cmp_ge_u32 s73, 15
    s_cselect_b32 s68, s72, s67
    s_mov_b32 m0, 87040
    s_add_u32 s68, s68, 27648
    buffer_load_dwordx4 v10, s[36:39], s68 offen offset:0 nt lds
    buffer_load_dwordx4 v11, s[36:39], s68 offen offset:1024 nt lds
    buffer_load_dwordx4 v12, s[36:39], s68 offen offset:2048 nt lds
    s_mov_b32 m0, 157696
    s_movk_i32 s70, 12288
    buffer_load_dwordx4 v4, s[44:47], s70 offen offset:0 lds
    buffer_load_dwordx4 v4, s[44:47], s70 offen offset:1024 lds
    buffer_load_dwordx4 v4, s[44:47], s70 offen offset:2048 lds
    s_mov_b32 m0, 44032
    s_add_u32 s69, s69, 3072
    buffer_load_dwordx4 v4, s[40:43], s69 offen offset:0 nt lds
    buffer_load_dwordx4 v4, s[40:43], s69 offen offset:1024 nt lds
    buffer_load_dwordx4 v4, s[40:43], s69 offen offset:2048 nt lds
    s_mov_b32 m0, 160768
    s_movk_i32 s70, 15360
    buffer_load_dwordx4 v4, s[44:47], s70 offen offset:0 lds
    buffer_load_dwordx4 v4, s[44:47], s70 offen offset:1024 lds
    buffer_load_dwordx4 v4, s[44:47], s70 offen offset:2048 lds
    s_waitcnt vmcnt(42)
    ds_write_b32 v5, v13 offset:6752
    v_add_u32 v13, 1, v13
    s_cmp_ge_u32 s73, 22
    s_cselect_b32 s68, s72, s67
    s_mov_b32 m0, 90112
    s_branch L_pads2
L_pad7:
    s_branch L_padret
L_pads2:
    s_add_u32 s68, s68, 79872
    buffer_load_dwordx4 v10, s[36:39], s68 offen offset:0 nt lds
    buffer_load_dwordx4 v11, s[36:39], s68 offen offset:1024 nt lds
    buffer_load_dwordx4 v12, s[36:39], s68 offen offset:2048 nt lds
    s_waitcnt vmcnt(42)
    ds_write_b32 v5, v13 offset:6752
    v_add_u32 v13, 1, v13
    s_cmp_ge_u32 s73, 21
    s_cselect_b32 s68, s72, s67
    s_mov_b32 m0, 93184
    s_add_u32 s68, s68, 82944
    buffer_load_dwordx4 v10, s[36:39], s68 offen offset:0 nt lds
    buffer_load_dwordx4 v11, s[36:39], s68 offen offset:1024 nt lds
    buffer_load_dwordx4 v12, s[36:39], s68 offen offset:2048 nt lds
    s_mov_b32 m0, 7168
    s_movk_i32 s70, 0
    buffer_load_dwordx4 v10, s[52:55], s70 offen offset:0 lds
    buffer_load_dwordx4 v11, s[52:55], s70 offen offset:1024 lds
    buffer_load_dwordx4 v12, s[52:55], s70 offen offset:2048 lds
    s_waitcnt vmcnt(42)
    ds_write_b32 v5, v13 offset:6752
    v_add_u32 v13, 1, v13
    s_mov_b32 m0, 47104
    s_add_u32 s69, s69, 3072
    buffer_load_dwordx4 v4, s[40:43], s69 offen offset:0 nt lds
    buffer_load_dwordx4 v4, s[40:43], s69 offen offset:1024 nt lds
    buffer_load_dwordx4 v4, s[40:43], s69 offen offset:2048 nt lds
    s_mov_b32 m0, 10240
    s_movk_i32 s70, 3072
    buffer_load_dwordx4 v10, s[52:55], s70 offen offset:0 lds
    buffer_load_dwordx4 v11, s[52:55], s70 offen offset:1024 lds
    buffer_load_dwordx4 v12, s[52:55], s70 offen offset:2048 lds
    s_waitcnt vmcnt(42)
    ds_write_b32 v5, v13 offset:6752
    v_add_u32 v13, 1, v13
    s_cmp_ge_u32 s73, 20
    s_cselect_b32 s68, s72, s67
    s_mov_b32 m0, 96256
    s_add_u32 s68, s68, 86016
    buffer_load_dwordx4 v10, s[36:39], s68 offen offset:0 nt lds
    buffer_load_dwordx4 v11, s[36:39], s68 offen offset:1024 nt lds
    buffer_load_dwordx4 v12, s[36:39], s68 offen offset:2048 nt lds
    s_mov_b32 m0, 13312
    s_movk_i32 s70, 6144
    buffer_load_dwordx4 v10, s[52:55], s70 offen offset:0 lds
    buffer_load_dwordx4 v11, s[52:55], s70 offen offset:1024 lds
    buffer_load_dwordx4 v12, s[52:55], s70 offen offset:2048 lds
    s_cmp_ge_u32 s73, 19
    s_cselect_b32 s68, s72, s67
    s_mov_b32 m0, 99328
    s_add_u32 s68, s68, 89088
    buffer_load_dwordx4 v10, s[36:39], s68 offen offset:0 nt lds
    buffer_load_dwordx4 v11, s[36:39], s68 offen offset:1024 nt lds
    buffer_load_dwordx4 v12, s[36:39], s68 offen offset:2048 nt lds
    s_mov_b32 m0, 16384
    s_movk_i32 s70, 9216
    buffer_load_dwordx4 v10, s[52:55], s70 offen offset:0 lds
    buffer_load_dwordx4 v11, s[52:55], s70 offen offset:1024 lds
    buffer_load_dwordx4 v12, s[52:55], s70 offen offset:2048 lds
    s_waitcnt vmcnt(42)
    ds_write_b32 v5, v13 offset:6752
    v_add_u32 v13, 1, v13
    s_mov_b32 m0, 50176
    s_add_u32 s69, s69, 3072
    buffer_load_dwordx4 v4, s[40:43], s69 offen offset:0 nt lds
    buffer_load_dwordx4 v4, s[40:43], s69 offen offset:1024 nt lds
    buffer_load_dwordx4 v4, s[40:43], s69 offen offset:2048 nt lds
    s_mov_b32 m0, 19456
    s_movk_i32 s70, 12288
    buffer_load_dwordx4 v10, s[52:55], s70 offen offset:0 lds
    buffer_load_dwordx4 v11, s[52:55], s70 offen offset:1024 lds
    buffer_load_dwordx4 v12, s[52:55], s70 offen offset:2048 lds
    s_waitcnt vmcnt(42)
    ds_write_b32 v5, v13 offset:6752
    v_add_u32 v13, 1, v13
    s_cmp_ge_u32 s73, 18
    s_cselect_b32 s68, s72, s67
    s_mov_b32 m0, 102400
    s_add_u32 s68, s68, 92160
    buffer_load_dwordx4 v10, s[36:39], s68 offen offset:0 nt lds
    buffer_load_dwordx4 v11, s[36:39], s68 offen offset:1024 nt lds
    buffer_load_dwordx4 v12, s[36:39], s68 offen offset:2048 nt lds
    s_mov_b32 m0, 22528
    s_movk_i32 s70, 15360
    buffer_load_dwordx4 v10, s[52:55], s70 offen offset:0 lds
    buffer_load_dwordx4 v11, s[52:55], s70 offen offset:1024 lds
    buffer_load_dwordx4 v12, s[52:55], s70 offen offset:2048 lds
    s_cmp_ge_u32 s73, 17
    s_cselect_b32 s68, s72, s67
    s_mov_b32 m0, 105472
    s_add_u32 s68, s68, 95232
    buffer_load_dwordx4 v10, s[36:39], s68 offen offset:0 nt lds
    buffer_load_dwordx4 v11, s[36:39], s68 offen offset:1024 nt lds
    buffer_load_dwordx4 v12, s[36:39], s68 offen offset:2048 nt lds
    s_waitcnt vmcnt(42)
    ds_write_b32 v5, v13 offset:6768
    s_cmp_ge_u32 s73, 16
    s_cselect_b32 s68, s72, s67
    s_mov_b32 m0, 108544
    s_add_u32 s68, s68, 98304
    buffer_load_dwordx4 v10, s[36:39], s68 offen offset:0 nt lds
    buffer_load_dwordx4 v11, s[36:39], s68 offen offset:1024 nt lds
    buffer_load_dwordx4 v12, s[36:39], s68 offen offset:2048 nt lds
    s_waitcnt vmcnt(42)
    ds_write_b32 v5, v13 offset:6752
    v_add_u32 v13, 1, v13
    s_cmp_ge_u32 s73, 15
    s_cselect_b32 s68, s72, s67
    s_mov_b32 m0, 111616
    s_add_u32 s68, s68, 101376
    buffer_load_dwordx4 v10, s[36:39], s68 offen offset:0 nt lds
    buffer_load_dwordx4 v11, s[36:39], s68 offen offset:1024 nt lds
    buffer_load_dwordx4 v12, s[36:39], s68 offen offset:2048 nt lds
    s_waitcnt vmcnt(42)
    ds_write_b32 v5, v13 offset:6752
    v_add_u32 v13, 1, v13
    s_cmp_ge_u32 s73, 14
    s_cselect_b32 s68, s72, s67
    s_mov_b32 m0, 114688
    s_add_u32 s68, s68, 30720
    buffer_load_dwordx4 v10, s[36:39], s68 offen offset:0 nt lds
    buffer_load_dwordx4 v11, s[36:39], s68 offen offset:1024 nt lds
    buffer_load_dwordx4 v12, s[36:39], s68 offen offset:2048 nt lds
    s_cmp_ge_u32 s73, 13
    s_cselect_b32 s68, s72, s67
    s_mov_b32 m0, 117760
    s_add_u32 s68, s68, 33792
    buffer_load_dwordx4 v10, s[36:39], s68 offen offset:0 nt lds
    buffer_load_dwordx4 v11, s[36:39], s68 offen offset:1024 nt lds
    buffer_load_dwordx4 v12, s[36:39], s68 offen offset:2048 nt lds
    s_branch L_pads3
L_pad8:
    s_branch L_padret
L_pads3:
    s_branch L_pads4
L_pad9:
    s_branch L_padret
L_pads4:
    s_cmp_ge_u32 s73, 12
    s_cselect_b32 s68, s72, s67
    s_mov_b32 m0, 120832
    s_add_u32 s68, s68, 36864
    buffer_load_dwordx4 v10, s[36:39], s68 offen offset:0 nt lds
    buffer_load_dwordx4 v11, s[36:39], s68 offen offset:1024 nt lds
    buffer_load_dwordx4 v12, s[36:39], s68 offen offset:2048 nt lds
    s_cmp_ge_u32 s73, 11
    s_cselect_b32 s68, s72, s67
    s_mov_b32 m0, 123904
    s_add_u32 s68, s68, 39936
    buffer_load_dwordx4 v10, s[36:39], s68 offen offset:0 nt lds
    buffer_load_dwordx4 v11, s[36:39], s68 offen offset:1024 nt lds
    buffer_load_dwordx4 v12, s[36:39], s68 offen offset:2048 nt lds
    s_waitcnt vmcnt(42)
    ds_write_b32 v5, v13 offset:6752
    v_add_u32 v13, 1, v13
L_w2:
    ds_read_b128 v[16:19], v5 offset:6688
    s_add_u32 s82, s82, 1
    s_cmp_gt_u32 s82, 4194304
    s_cbranch_scc1 L_end
    s_waitcnt lgkmcnt(0)
    v_min3_u32 v16, v16, v17, v18
    v_cmp_eq_u32 vcc, 0, v16
    s_cbranch_vccnz L_w2
    s_cmp_ge_u32 s73, 10
    s_cselect_b32 s68, s72, s67
    s_mov_b32 m0, 126976
    s_add_u32 s68, s68, 43008
    buffer_load_dwordx4 v10, s[36:39], s68 offen offset:0 nt lds
    buffer_load_dwordx4 v11, s[36:39], s68 offen offset:1024 nt lds
    buffer_load_dwordx4 v12, s[36:39], s68 offen offset:2048 nt lds
    s_cmp_ge_u32 s73, 9
    s_cselect_b32 s68, s72, s67
    s_mov_b32 m0, 130048
    s_add_u32 s68, s68, 46080
    buffer_load_dwordx4 v10, s[36:39], s68 offen offset:0 nt lds
    buffer_load_dwordx4 v11, s[36:39], s68 offen offset:1024 nt lds
    buffer_load_dwordx4 v12, s[36:39], s68 offen offset:2048 nt lds
    s_waitcnt vmcnt(42)
    ds_write_b32 v5, v13 offset:6752
    v_add_u32 v13, 1, v13
    s_cmp_ge_u32 s73, 8
    s_cselect_b32 s68, s72, s67
    s_mov_b32 m0, 133120
    s_add_u32 s68, s68, 49152
    buffer_load_dwordx4 v10, s[36:39], s68 offen offset:0 nt lds
    buffer_load_dwordx4 v11, s[36:39], s68 offen offset:1024 nt lds
    buffer_load_dwordx4 v12, s[36:39], s68 offen offset:2048 nt lds
    s_cmp_ge_u32 s73, 7
    s_cselect_b32 s68, s72, s67
    s_mov_b32 m0, 136192
    s_add_u32 s68, s68, 52224
    buffer_load_dwordx4 v10, s[36:39], s68 offen offset:0 nt lds
    buffer_load_dwordx4 v11, s[36:39], s68 offen offset:1024 nt lds
    buffer_load_dwordx4 v12, s[36:39], s68 offen offset:2048 nt lds
    s_cmp_ge_u32 s73, 14
    s_cselect_b32 s68, s72, s67
    s_mov_b32 m0, 139264
    s_add_u32 s68, s68, 104448
    buffer_load_dwordx4 v10, s[36:39], s68 offen offset:0 nt lds
    buffer_load_dwordx4 v11, s[36:39], s68 offen offset:1024 nt lds
    buffer_load_dwordx4 v12, s[36:39], s68 offen offset:2048 nt lds
    s_cmp_ge_u32 s73, 13
    s_cselect_b32 s68, s72, s67
    s_mov_b32 m0, 142336
    s_add_u32 s68, s68, 107520
    buffer_load_dwordx4 v10, s[36:39], s68 offen offset:0 nt lds
    buffer_load_dwordx4 v11, s[36:39], s68 offen offset:1024 nt lds
    buffer_load_dwordx4 v12, s[36:39], s68 offen offset:2048 nt lds
    s_waitcnt vmcnt(42)
    ds_write_b32 v5, v13 offset:6752
    v_add_u32 v13, 1, v13
L_w3:
    ds_read_b128 v[16:19], v5 offset:6704
    s_add_u32 s82, s82, 1
    s_cmp_gt_u32 s82, 4194304
    s_cbranch_scc1 L_end
    s_waitcnt lgkmcnt(0)
    v_min3_u32 v16, v16, v17, v18
    v_cmp_eq_u32 vcc, 0, v16
    s_cbranch_vccnz L_w3
    s_cmp_ge_u32 s73, 12
    s_cselect_b32 s68, s72, s67
    s_mov_b32 m0, 145408
    s_add_u32 s68, s68, 110592
    buffer_load_dwordx4 v10, s[36:39], s68 offen offset:0 nt lds
    buffer_load_dwordx4 v11, s[36:39], s68 offen offset:1024 nt lds
    buffer_load_dwordx4 v12, s[36:39], s68 offen offset:2048 nt lds
    s_waitcnt vmcnt(42)
    ds_write_b32 v5, v13 offset:6764
    s_cmp_ge_u32 s73, 11
    s_cselect_b32 s68, s72, s67
    s_mov_b32 m0, 148480
    s_add_u32 s68, s68, 113664
    buffer_load_dwordx4 v10, s[36:39], s68 offen offset:0 nt lds
    buffer_load_dwordx4 v11, s[36:39], s68 offen offset:1024 nt lds
    buffer_load_dwordx4 v12, s[36:39], s68 offen offset:2048 nt lds
    s_waitcnt vmcnt(42)
    ds_write_b32 v5, v13 offset:6752
    v_add_u32 v13, 1, v13
    s_cmp_ge_u32 s73, 10
    s_cselect_b32 s68, s72, s67
    s_mov_b32 m0, 151552
    s_add_u32 s68, s68, 116736
    buffer_load_dwordx4 v10, s[36:39], s68 offen offset:0 nt lds
    buffer_load_dwordx4 v11, s[36:39], s68 offen offset:1024 nt lds
    buffer_load_dwordx4 v12, s[36:39], s68 offen offset:2048 nt lds
    s_waitcnt vmcnt(42)
    ds_write_b32 v5, v13 offset:6752
    v_add_u32 v13, 1, v13
    s_cmp_ge_u32 s73, 9
    s_cselect_b32 s68, s72, s67
    s_mov_b32 m0, 154624
    s_add_u32 s68, s68, 119808
    buffer_load_dwordx4 v10, s[36:39], s68 offen offset:0 nt lds
    buffer_load_dwordx4 v11, s[36:39], s68 offen offset:1024 nt lds
    buffer_load_dwordx4 v12, s[36:39], s68 offen offset:2048 nt lds
    s_waitcnt vmcnt(42)
    ds_write_b32 v5, v13 offset:6752
    v_add_u32 v13, 1, v13
    s_cmp_ge_u32 s73, 8
    s_cselect_b32 s68, s72, s67
    s_mov_b32 m0, 157696
    s_add_u32 s68, s68, 122880
    buffer_load_dwordx4 v10, s[36:39], s68 offen offset:0 nt lds
    buffer_load_dwordx4 v11, s[36:39], s68 offen offset:1024 nt lds
    buffer_load_dwordx4 v12, s[36:39], s68 offen offset:2048 nt lds
    s_waitcnt vmcnt(42)
    ds_write_b32 v5, v13 offset:6752
    v_add_u32 v13, 1, v13
    s_cmp_ge_u32 s73, 7
    s_cselect_b32 s68, s72, s67
    s_mov_b32 m0, 160768
    s_add_u32 s68, s68, 125952
    buffer_load_dwordx4 v10, s[36:39], s68 offen offset:0 nt lds
    buffer_load_dwordx4 v11, s[36:39], s68 offen offset:1024 nt lds
    buffer_load_dwordx4 v12, s[36:39], s68 offen offset:2048 nt lds
    s_branch L_pads5
L_pad0:
    s_branch L_padret
L_pads5:
    s_waitcnt vmcnt(42)
    ds_write_b32 v5, v13 offset:6752
    v_add_u32 v13, 1, v13
    s_waitcnt vmcnt(39)
    ds_write_b32 v5, v13 offset:6752
    v_add_u32 v13, 1, v13
    s_waitcnt vmcnt(36)
    ds_write_b32 v5, v13 offset:6752
    v_add_u32 v13, 1, v13
    s_waitcnt vmcnt(33)
    ds_write_b32 v5, v13 offset:6752
    v_add_u32 v13, 1, v13
    s_waitcnt vmcnt(30)
    ds_write_b32 v5, v13 offset:6752
    v_add_u32 v13, 1, v13
    s_waitcnt vmcnt(27)
    ds_write_b32 v5, v13 offset:6752
    v_add_u32 v13, 1, v13
    s_waitcnt vmcnt(24)
    ds_write_b32 v5, v13 offset:6752
    v_add_u32 v13, 1, v13
    s_waitcnt vmcnt(21)
    ds_write_b32 v5, v13 offset:6752
    v_add_u32 v13, 1, v13
    s_waitcnt vmcnt(18)
    ds_write_b32 v5, v13 offset:6752
    v_add_u32 v13, 1, v13
    s_waitcnt vmcnt(15)
    ds_write_b32 v5, v13 offset:6752
    v_add_u32 v13, 1, v13
    s_waitcnt vmcnt(12)
    ds_write_b32 v5, v13 offset:6752
    v_add_u32 v13, 1, v13
    s_waitcnt vmcnt(9)
    ds_write_b32 v5, v13 offset:6752
    v_add_u32 v13, 1, v13
    s_waitcnt vmcnt(6)
    ds_write_b32 v5, v13 offset:6752
    v_add_u32 v13, 1, v13
    s_waitcnt vmcnt(3)
    ds_write_b32 v5, v13 offset:6752
    v_add_u32 v13, 1, v13
    s_waitcnt vmcnt(0)
    ds_write_b32 v5, v13 offset:6752
    v_add_u32 v13, 1, v13
    s_branch L_fin
L_helper:
    s_mov_b32 s56, s34
    s_and_b32 s57, s35, 0xffff
    s_mov_b32 s58, 268435456
    s_mov_b32 s59, 0x00020000
    s_add_u32 s6, s34, 4194304
    s_addc_u32 s7, s35, 0
    s_load_dword s78, s[6:7], 0
    v_lshrrev_b32 v6, 2, v2
    v_lshl_add_u32 v6, v3, 3, v6
    v_lshlrev_b32 v12, 6, v6
    v_lshl_add_u32 v12, v7, 3, v12
    v_add_u32 v12, s72, v12
    v_mov_b32 v16, 1
    s_lshl_b32 s70, s4, 2
    v_mov_b32 v17, s70
    s_lshl_b32 s70, s4, 10
    v_add_u32 v13, s70, v4
    v_lshrrev_b32 v6, 1, v2
    v_and_b32 v6, 2, v6
    v_xor_b32 v6, v6, v3
    v_mul_u32_u24 v18, 192, v2
    v_lshl_add_u32 v18, v6, 4, v18
    s_sub_u32 s70, s72, 18432
    v_add_u32 v18, s70, v18
    v_mul_u32_u24 v14, 208, v2
    v_lshl_add_u32 v19, v3, 4, v14
    v_lshl_add_u32 v15, v3, 3, v14
    s_lshl_b32 s70, s4, 6
    v_add_u32 v15, s70, v15
    v_add_u32 v50, v14, v17
    s_mov_b32 s64, 0x00003f80
    s_mov_b32 s65, 0x3f800000
    s_mov_b32 s66, 0x3f803f80
    s_add_u32 s83, s4, 4
    s_waitcnt vmcnt(6) lgkmcnt(0)
    ds_write_b32 v17, v16 offset:6816
L_w4:
    ds_read_b128 v[36:39], v5 offset:6816
    ds_read_b128 v[136:139], v10 offset:0
    ds_read_b128 v[140:143], v10 offset:64
    ds_read_b128 v[144:147], v10 offset:128
    s_add_u32 s82, s82, 1
    s_cmp_gt_u32 s82, 4194304
    s_cbranch_scc1 L_end
    s_waitcnt lgkmcnt(0)
    v_min3_u32 v36, v36, v37, v38
    v_cmp_eq_u32 vcc, 0, v36
    s_cbranch_vccnz L_w4
    v_dot2_f32_bf16 v8, v136, s66, 0
    v_dot2_f32_bf16 v9, v136, v136, 0
    v_dot2_f32_bf16 v8, v137, s66, v8
    v_dot2_f32_bf16 v9, v137, v137, v9
    v_dot2_f32_bf16 v8, v138, s66, v8
    v_dot2_f32_bf16 v9, v138, v138, v9
    v_dot2_f32_bf16 v8, v139, s66, v8
    v_dot2_f32_bf16 v9, v139, v139, v9
    v_dot2_f32_bf16 v8, v140, s66, v8
    v_dot2_f32_bf16 v9, v140, v140, v9
    v_dot2_f32_bf16 v8, v141, s66, v8
    v_dot2_f32_bf16 v9, v141, v141, v9
    v_dot2_f32_bf16 v8, v142, s66, v8
    v_dot2_f32_bf16 v9, v142, v142, v9
    v_dot2_f32_bf16 v8, v143, s66, v8
    v_dot2_f32_bf16 v9, v143, v143, v9
    v_dot2_f32_bf16 v8, v144, s66, v8
    v_dot2_f32_bf16 v9, v144, v144, v9
    v_dot2_f32_bf16 v8, v145, s66, v8
    v_dot2_f32_bf16 v9, v145, v145, v9
    v_dot2_f32_bf16 v8, v146, s66, v8
    v_dot2_f32_bf16 v9, v146, v146, v9
    v_dot2_f32_bf16 v8, v147, s66, v8
    v_dot2_f32_bf16 v9, v147, v147, v9
    s_nop 1
    v_mov_b32 v6, v8
    v_mov_b32 v7, v9
    s_nop 0
    v_permlane32_swap_b32 v8, v6
    v_permlane32_swap_b32 v9, v7
    v_add_f32 v8, v8, v6
    v_add_f32 v9, v9, v7
    v_mov_b32 v6, v8
    v_mov_b32 v7, v9
    s_nop 0
    v_permlane16_swap_b32 v8, v6
    v_permlane16_swap_b32 v9, v7
    v_add_f32 v8, v8, v6
    v_add_f32 v9, v9, v7
    v_mul_f32 v8, 0xbc2aaaab, v8
    v_mul_f32 v9, 0x3c2aaaab, v9
    v_fma_f32 v9, -v8, v8, v9
    v_max_f32 v9, 0, v9
    v_add_f32 v9, 0x3727c5ac, v9
    v_rsq_f32 v9, v9
    v_dot2_f32_bf16 v100, v136, s64, v8
    v_dot2_f32_bf16 v101, v136, s65, v8
    v_dot2_f32_bf16 v102, v137, s64, v8
    v_dot2_f32_bf16 v103, v137, s65, v8
    v_dot2_f32_bf16 v104, v138, s64, v8
    v_dot2_f32_bf16 v105, v138, s65, v8
    v_dot2_f32_bf16 v106, v139, s64, v8
    v_dot2_f32_bf16 v107, v139, s65, v8
    v_dot2_f32_bf16 v108, v140, s64, v8
    s_branch L_pads6
L_pad1:
    s_branch L_padret
L_pads6:
    v_dot2_f32_bf16 v109, v140, s65, v8
    v_dot2_f32_bf16 v110, v141, s64, v8
    v_dot2_f32_bf16 v111, v141, s65, v8
    v_dot2_f32_bf16 v112, v142, s64, v8
    v_dot2_f32_bf16 v113, v142, s65, v8
    v_dot2_f32_bf16 v114, v143, s64, v8
    v_dot2_f32_bf16 v115, v143, s65, v8
    v_dot2_f32_bf16 v116, v144, s64, v8
    v_dot2_f32_bf16 v117, v144, s65, v8
    v_dot2_f32_bf16 v118, v145, s64, v8
    v_dot2_f32_bf16 v119, v145, s65, v8
    v_dot2_f32_bf16 v120, v146, s64, v8
    v_dot2_f32_bf16 v121, v146, s65, v8
    v_dot2_f32_bf16 v122, v147, s64, v8
    v_dot2_f32_bf16 v123, v147, s65, v8
    s_waitcnt vmcnt(0) lgkmcnt(0)
    ds_read_b64_tr_b16 v[64:65], v12 offset:0
    ds_read_b64_tr_b16 v[66:67], v12 offset:256
    ds_read_b64_tr_b16 v[68:69], v12 offset:2048
    ds_read_b64_tr_b16 v[70:71], v12 offset:2304
    ds_read_b64_tr_b16 v[72:73], v12 offset:4096
    ds_read_b64_tr_b16 v[74:75], v12 offset:4352
    ds_read_b64_tr_b16 v[76:77], v12 offset:32
    ds_read_b64_tr_b16 v[78:79], v12 offset:288
    ds_read_b64_tr_b16 v[80:81], v12 offset:2080
    ds_read_b64_tr_b16 v[82:83], v12 offset:2336
    ds_read_b64_tr_b16 v[84:85], v12 offset:4128
    ds_read_b64_tr_b16 v[86:87], v12 offset:4384
    v_pk_mul_f32 v[100:101], v[100:101], v[8:9] op_sel:[0,1] op_sel_hi:[1,1]
    v_pk_mul_f32 v[102:103], v[102:103], v[8:9] op_sel:[0,1] op_sel_hi:[1,1]
    v_pk_mul_f32 v[104:105], v[104:105], v[8:9] op_sel:[0,1] op_sel_hi:[1,1]
    v_pk_mul_f32 v[106:107], v[106:107], v[8:9] op_sel:[0,1] op_sel_hi:[1,1]
    v_pk_mul_f32 v[108:109], v[108:109], v[8:9] op_sel:[0,1] op_sel_hi:[1,1]
    v_pk_mul_f32 v[110:111], v[110:111], v[8:9] op_sel:[0,1] op_sel_hi:[1,1]
    v_pk_mul_f32 v[112:113], v[112:113], v[8:9] op_sel:[0,1] op_sel_hi:[1,1]
    v_pk_mul_f32 v[114:115], v[114:115], v[8:9] op_sel:[0,1] op_sel_hi:[1,1]
    v_pk_mul_f32 v[116:117], v[116:117], v[8:9] op_sel:[0,1] op_sel_hi:[1,1]
    v_pk_mul_f32 v[118:119], v[118:119], v[8:9] op_sel:[0,1] op_sel_hi:[1,1]
    v_pk_mul_f32 v[120:121], v[120:121], v[8:9] op_sel:[0,1] op_sel_hi:[1,1]
    v_pk_mul_f32 v[122:123], v[122:123], v[8:9] op_sel:[0,1] op_sel_hi:[1,1]
    v_cvt_pk_bf16_f32 v136, v100, v101
    v_cvt_pk_bf16_f32 v137, v102, v103
    v_cvt_pk_bf16_f32 v138, v104, v105
    v_cvt_pk_bf16_f32 v139, v106, v107
    v_cvt_pk_bf16_f32 v140, v108, v109
    v_cvt_pk_bf16_f32 v141, v110, v111
    v_cvt_pk_bf16_f32 v142, v112, v113
    v_cvt_pk_bf16_f32 v143, v114, v115
    v_cvt_pk_bf16_f32 v144, v116, v117
    v_cvt_pk_bf16_f32 v145, v118, v119
    v_cvt_pk_bf16_f32 v146, v120, v121
    v_cvt_pk_bf16_f32 v147, v122, v123
    s_waitcnt lgkmcnt(0)
    v_mfma_f32_16x16x32_bf16 v[28:31], v[64:67], v[136:139], 0
    v_mfma_f32_16x16x32_bf16 v[32:35], v[76:79], v[136:139], 0
    v_mfma_f32_16x16x32_bf16 v[28:31], v[68:71], v[140:143], v[28:31]
    v_mfma_f32_16x16x32_bf16 v[32:35], v[80:83], v[140:143], v[32:35]
    v_mfma_f32_16x16x32_bf16 v[28:31], v[72:75], v[144:147], v[28:31]
    v_mfma_f32_16x16x32_bf16 v[32:35], v[84:87], v[144:147], v[32:35]
    s_nop 6
    v_cvt_pk_bf16_f32 v44, v28, v29
    v_cvt_pk_bf16_f32 v45, v30, v31
    v_cvt_pk_bf16_f32 v46, v32, v33
    v_cvt_pk_bf16_f32 v47, v34, v35
    ds_write_b64 v15, v[44:45] offset:3328
    ds_write_b64 v15, v[46:47] offset:3360
    ds_write_b32 v17, v16 offset:6656
L_w5:
    ds_read_b128 v[36:39], v5 offset:6656
    ds_read_b128 v[136:139], v19 offset:3328
    ds_read_b128 v[140:143], v19 offset:3392
    ds_read_b128 v[144:147], v19 offset:3456
    s_add_u32 s82, s82, 1
    s_cmp_gt_u32 s82, 4194304
    s_cbranch_scc1 L_end
    s_waitcnt lgkmcnt(3)
    v_min3_u32 v36, v36, v37, v38
    v_cmp_eq_u32 vcc, 0, v36
    s_cbranch_vccnz L_w5
    v_mov_b32 v52, 0x3f803f80
    v_mov_b32 v53, 0x3f803f80
    v_mov_b32 v54, 0x3f803f80
    v_mov_b32 v55, 0x3f803f80
    v_mov_b32 v56, 0x3f803f80
    v_mov_b32 v57, 0x3f803f80
    v_mov_b32 v58, 0x3f803f80
    v_mov_b32 v59, 0x3f803f80
    v_mov_b32 v60, 0x3f803f80
    v_mov_b32 v61, 0x3f803f80
    v_mov_b32 v62, 0x3f803f80
    v_mov_b32 v63, 0x3f803f80
    v_mov_b32 v100, 0
    v_mov_b32 v101, 0
    v_mov_b32 v102, 0
    v_mov_b32 v103, 0
    v_mov_b32 v104, 0
    v_mov_b32 v105, 0
    v_mov_b32 v106, 0
    v_mov_b32 v107, 0
    v_mov_b32 v108, 0
    v_mov_b32 v109, 0
    v_mov_b32 v110, 0
    v_mov_b32 v111, 0
    v_mov_b32 v112, 0
    v_mov_b32 v113, 0
    v_mov_b32 v114, 0
    v_mov_b32 v115, 0
    v_mov_b32 v116, 0
    v_mov_b32 v117, 0
    v_mov_b32 v118, 0
    v_mov_b32 v119, 0
    v_mov_b32 v120, 0
    v_mov_b32 v121, 0
    v_mov_b32 v122, 0
    v_mov_b32 v123, 0
L_w6:
    ds_read_b32 v6, v5 offset:6760
    s_add_u32 s82, s82, 1
    s_cmp_gt_u32 s82, 4194304
    s_cbranch_scc1 L_end
    s_waitcnt lgkmcnt(0)
    v_cmp_eq_u32 vcc, 0, v6
    s_cbranch_vccnz L_w6
    ds_read_b128 v[64:67], v18 offset:0
    ds_read_b128 v[68:71], v18 offset:64
    ds_read_b128 v[72:75], v18 offset:128
    ds_read_b128 v[76:79], v18 offset:3072
    ds_read_b128 v[80:83], v18 offset:3136
    ds_read_b128 v[84:87], v18 offset:3200
    s_waitcnt lgkmcnt(0)
    v_mfma_f32_16x16x32_bf16 v[28:31], v[64:67], v[136:139], 0
    s_branch L_pads7
L_pad2:
    s_branch L_padret
L_pads7:
    v_mfma_f32_16x16x32_bf16 v[32:35], v[76:79], v[136:139], 0
    v_mfma_f32_16x16x32_bf16 v[28:31], v[68:71], v[140:143], v[28:31]
    v_mfma_f32_16x16x32_bf16 v[32:35], v[80:83], v[140:143], v[32:35]
    v_mfma_f32_16x16x32_bf16 v[28:31], v[72:75], v[144:147], v[28:31]
    v_mfma_f32_16x16x32_bf16 v[32:35], v[84:87], v[144:147], v[32:35]
    s_nop 6
    v_add_f32 v8, v28, v29
    v_add_f32 v9, v30, v31
    v_add_f32 v6, v32, v33
    v_add_f32 v7, v34, v35
    v_add_f32 v8, v8, v9
    v_add_f32 v6, v6, v7
    v_add_f32 v8, v8, v6
    v_mov_b32 v9, v8
    s_nop 1
    v_permlane32_swap_b32 v8, v9
    v_add_f32 v8, v8, v9
    v_mov_b32 v9, v8
    s_nop 1
    v_permlane16_swap_b32 v8, v9
    v_add_f32 v8, v8, v9
    ds_write_b32 v50, v8 offset:192
    ds_write_b32 v17, v16 offset:6672
    v_mov_b32 v9, 0x3e16c740
L_w7:
    ds_read_b128 v[36:39], v5 offset:6672
    ds_read_b128 v[40:43], v14 offset:192
    s_add_u32 s82, s82, 1
    s_cmp_gt_u32 s82, 4194304
    s_cbranch_scc1 L_end
    s_waitcnt lgkmcnt(0)
    v_min3_u32 v36, v36, v37, v38
    v_cmp_eq_u32 vcc, 0, v36
    s_cbranch_vccnz L_w7
    v_add_f32 v8, v40, v41
    v_add_f32 v8, v8, v42
    v_mul_f32 v8, 0xbac909aa, v8
    v_fma_f32 v28, v28, v9, v8
    v_fma_f32 v29, v29, v9, v8
    v_fma_f32 v30, v30, v9, v8
    v_fma_f32 v31, v31, v9, v8
    v_fma_f32 v32, v32, v9, v8
    v_fma_f32 v33, v33, v9, v8
    v_fma_f32 v34, v34, v9, v8
    v_fma_f32 v35, v35, v9, v8
    v_cvt_pk_bf16_f32 v44, v28, v29
    v_cvt_pk_bf16_f32 v45, v30, v31
    v_cvt_pk_bf16_f32 v46, v32, v33
    v_cvt_pk_bf16_f32 v47, v34, v35
    ds_write2_b64 v15, v[44:45], v[46:47] offset0:0 offset1:4
    ds_write_b32 v17, v16 offset:6688
    s_branch L_comp2
L_comp:
    s_mov_b32 s56, s34
    s_and_b32 s57, s35, 0xffff
    s_mov_b32 s58, 268435456
    s_mov_b32 s59, 0x00020000
    s_mov_b32 s44, s16
    s_and_b32 s45, s17, 0xffff
    s_mov_b32 s46, 3072
    s_mov_b32 s47, 0x00020000
    s_add_u32 s6, s34, 4194304
    s_addc_u32 s7, s35, 0
    s_load_dword s78, s[6:7], 0
    s_mov_b32 s83, s4
L_comp2:
    s_setprio 2
    v_lshrrev_b32 v6, 1, v2
    v_and_b32 v7, 2, v6
    v_xor_b32 v7, v7, v3
    v_mul_u32_u24 v10, 192, v2
    v_lshl_add_u32 v10, v7, 4, v10
    v_mul_u32_u24 v11, 192, v6
    v_lshl_add_u32 v11, v3, 4, v11
    s_mov_b32 s74, 0xaaaaaaaa
    s_mov_b32 s75, 0xaaaaaaaa
    s_mov_b32 s76, 0xcccccccc
    s_mov_b32 s77, 0xcccccccc
    s_mov_b32 s8, 0x00f0000f
    s_mov_b32 s9, 0xf0000f00
    s_not_b64 s[10:11], s[74:75]
    v_lshrrev_b32 v6, 2, v1
    v_and_b32 v7, 3, v1
    v_lshlrev_b32 v7, 3, v7
    v_mul_u32_u24 v14, 192, v6
    v_and_b32 v8, 1, v3
    v_lshlrev_b32 v8, 5, v8
    v_add3_u32 v14, v14, v7, v8
    v_lshrrev_b32 v6, 1, v6
    v_mul_u32_u24 v15, 192, v6
    v_add_u32 v15, v15, v7
    v_cndmask_b32 v20, 0.5, 1.0, s[74:75]
    v_mov_b32 v21, 0x3c2aaaab
    v_mov_b32 v23, 0x3727c5ac
    v_cndmask_b32 v21, 0, v21, s[8:9]
    v_cndmask_b32 v150, 0, v23, s[8:9]
    v_add_f32 v149, v21, v21
    v_add_u32 v10, 53248, v10
    v_add_u32 v14, 53248, v14
    v_mov_b32 v24, 0x7fc00000
    v_mov_b32 v25, 0
    v_mul_u32_u24 v19, 208, v2
    s_mov_b32 s70, s83
    s_lshl_b32 s71, s70, 2
    s_mul_i32 s70, s70, 3072
    s_add_u32 s70, s70, 114688
    v_add_u32 v26, s70, v4
    v_mov_b32 v27, s71
    v_mov_b32 v148, 2
    s_add_u32 s73, s83, 2
    s_add_u32 s81, s83, 4
    s_lshr_b32 s70, s83, 2
    s_lshl_b32 s71, s70, 1
    s_and_b32 s72, s83, 3
    s_cmp_eq_u32 s72, 3
    s_cselect_b32 s73, s70, s73
    s_cselect_b32 s81, s71, s81
    s_cselect_b32 s72, 6, 4
    s_cselect_b32 s65, 1, 8
    s_mov_b32 s80, 0
    s_mov_b32 s64, 0x42800000
    s_mov_b32 s69, 0x5f800000
    s_cmp_lt_u32 s3, 3
    s_cbranch_scc1 L_cqk
    v_mov_b32 v52, 0x3f803f80
    v_mov_b32 v53, 0x3f803f80
    v_mov_b32 v54, 0x3f803f80
    v_mov_b32 v55, 0x3f803f80
    v_mov_b32 v56, 0x3f803f80
    v_mov_b32 v57, 0x3f803f80
    v_mov_b32 v58, 0x3f803f80
    v_mov_b32 v59, 0x3f803f80
    v_mov_b32 v60, 0x3f803f80
    v_mov_b32 v61, 0x3f803f80
    v_mov_b32 v62, 0x3f803f80
    v_mov_b32 v63, 0x3f803f80
    v_mov_b32 v100, 0
    v_mov_b32 v101, 0
    v_mov_b32 v102, 0
    v_mov_b32 v103, 0
    v_mov_b32 v104, 0
    v_mov_b32 v105, 0
    v_mov_b32 v106, 0
    v_mov_b32 v107, 0
    v_mov_b32 v108, 0
    v_mov_b32 v109, 0
    v_mov_b32 v110, 0
    v_mov_b32 v111, 0
    v_mov_b32 v112, 0
    v_mov_b32 v113, 0
    v_mov_b32 v114, 0
    s_branch L_pads8
L_pad3:
    s_branch L_padret
L_pads8:
    v_mov_b32 v115, 0
    v_mov_b32 v116, 0
    v_mov_b32 v117, 0
    v_mov_b32 v118, 0
    v_mov_b32 v119, 0
    v_mov_b32 v120, 0
    v_mov_b32 v121, 0
    v_mov_b32 v122, 0
    v_mov_b32 v123, 0
    s_branch L_w8_in
L_w8:
    s_sleep 2
L_w8_in:
    ds_read_b128 v[84:87], v5 offset:6656
    s_add_u32 s82, s82, 1
    s_cmp_gt_u32 s82, 4194304
    s_cbranch_scc1 L_end
    s_waitcnt lgkmcnt(0)
    v_min3_u32 v84, v84, v85, v86
    v_cmp_eq_u32 vcc, 0, v84
    s_cbranch_vccnz L_w8
    s_branch L_cpre
L_cqk:
    v_lshl_add_u32 v9, v3, 4, v19
L_w9:
    ds_read_b128 v[84:87], v5 offset:6688
    ds_read_b128 v[28:31], v9 offset:0
    ds_read_b128 v[32:35], v9 offset:64
    ds_read_b128 v[36:39], v9 offset:128
    s_add_u32 s82, s82, 1
    s_cmp_gt_u32 s82, 4194304
    s_cbranch_scc1 L_end
    s_waitcnt lgkmcnt(0)
    v_min3_u32 v84, v84, v85, v86
    v_cmp_eq_u32 vcc, 0, v84
    s_cbranch_vccnz L_w9
L_cpre:
    s_or_b32 s67, s73, 1
    s_branch L_w10_in
    .fill 88, 4, 0xbf800000
L_pad4:
    s_branch L_padret
L_w10:
    s_sleep 1
L_w10_in:
    ds_read_b32 v6, v5 offset:6752
    s_add_u32 s82, s82, 1
    s_cmp_gt_u32 s82, 4194304
    s_cbranch_scc1 L_end
    s_waitcnt lgkmcnt(0)
    v_cmp_gt_i32 vcc, s67, v6
    s_cbranch_vccnz L_w10
L_cpre2:
    s_mul_i32 s71, s73, 1536
    v_add_u32 v13, s71, v11
    v_add_u32 v18, s71, v15
    ds_read_b128 v[40:43], v13 offset:25600
    ds_read_b128 v[44:47], v13 offset:25664
    ds_read_b128 v[48:51], v13 offset:25728
    s_mov_b64 exec, s[10:11]
    ds_read_b128 v[52:55], v13 offset:25600
    ds_read_b128 v[56:59], v13 offset:25664
    ds_read_b128 v[60:63], v13 offset:25728
    s_mov_b64 exec, -1
    s_waitcnt lgkmcnt(0)
    v_mfma_f32_16x16x32_bf16 v[76:79], v[40:43], v[52:55], 0
    ds_read_b64_tr_b16 v[126:127], v18 offset:25600
    v_mfma_f32_16x16x32_bf16 v[76:79], v[44:47], v[56:59], v[76:79]
    ds_read_b64_tr_b16 v[130:131], v18 offset:25632
    v_mfma_f32_16x16x32_bf16 v[76:79], v[48:51], v[60:63], v[76:79]
    ds_read_b64_tr_b16 v[134:135], v18 offset:25664
    v_mfma_f32_16x16x32_bf16 v[80:83], v[40:43], v[28:31], 0
    ds_read_b64_tr_b16 v[138:139], v18 offset:25696
    v_mfma_f32_16x16x32_bf16 v[80:83], v[44:47], v[32:35], v[80:83]
    ds_read_b64_tr_b16 v[142:143], v18 offset:25728
    v_mfma_f32_16x16x32_bf16 v[80:83], v[48:51], v[36:39], v[80:83]
    ds_read_b64_tr_b16 v[146:147], v18 offset:25760
    s_nop 0
    v_mul_f32 v76, v76, v20
    v_mul_f32 v77, v77, v20
    v_mul_f32 v78, v78, v20
    v_mul_f32 v79, v79, v20
L_ctile:
    s_mul_i32 s70, s81, 3072
    s_mov_b32 s66, 0
    v_add_u32 v12, s70, v10
L_tl11_in:
    ds_read_b32 v6, v5 offset:6752
    ds_read_b128 v[64:67], v12 offset:0
    ds_read_b128 v[68:71], v12 offset:64
    ds_read_b128 v[72:75], v12 offset:128
    v_add_u32 v16, s70, v14
    v_xor_b32 v17, 32, v16
    s_waitcnt lgkmcnt(3)
    v_cmp_ge_i32 vcc, s81, v6
    v_sub_f32 v96, 0, v24
    v_sub_f32 v97, 0, v24
    v_sub_f32 v98, 0, v24
    v_sub_f32 v99, 0, v24
    s_cbranch_vccnz L_tl11
    s_waitcnt lgkmcnt(0)
    v_mfma_f32_16x16x32_bf16 v[88:91], v[64:67], v[52:55], v[76:79]
    ds_read_b64_tr_b16 v[124:125], v16 offset:0
    v_mfma_f32_16x16x32_bf16 v[88:91], v[68:71], v[56:59], v[88:91]
    ds_read_b64_tr_b16 v[128:129], v17 offset:0
    v_mfma_f32_16x16x32_bf16 v[88:91], v[72:75], v[60:63], v[88:91]
    ds_read_b64_tr_b16 v[132:133], v16 offset:64
    v_mfma_f32_16x16x32_bf16 v[84:87], v[64:67], v[64:67], 0
    ds_read_b64_tr_b16 v[136:137], v17 offset:64
    v_mfma_f32_16x16x32_bf16 v[84:87], v[68:71], v[68:71], v[84:87]
    ds_read_b64_tr_b16 v[140:141], v16 offset:128
    v_mfma_f32_16x16x32_bf16 v[84:87], v[72:75], v[72:75], v[84:87]
    ds_read_b64_tr_b16 v[144:145], v17 offset:128
    v_mfma_f32_16x16x32_bf16 v[92:95], v[64:67], v[28:31], v[80:83]
    v_cndmask_b32 v8, v88, v90, s[76:77]
    v_cndmask_b32 v9, v89, v91, s[76:77]
    s_mov_b64 vcc, s[74:75]
    v_mfma_f32_16x16x32_bf16 v[92:95], v[68:71], v[32:35], v[92:95]
    v_cndmask_b32_dpp v89, v8, v9, vcc quad_perm:[1,1,3,3] row_mask:0xf bank_mask:0xf
    v_mul_f32 v89, v21, v89
    s_mov_b64 vcc, s[10:11]
    v_mfma_f32_16x16x32_bf16 v[92:95], v[72:75], v[36:39], v[92:95]
    v_cndmask_b32_dpp v88, v9, v8, vcc quad_perm:[0,0,2,2] row_mask:0xf bank_mask:0xf
    v_fma_f32 v22, -v89, v89, v150
    v_cndmask_b32 v6, v85, v84, vcc
    v_cndmask_b32 v7, v87, v86, vcc
    v_fmac_f32 v22, v88, v149
    v_cndmask_b32 v6, v6, v7, s[76:77]
    v_fmac_f32 v22, v6, v21
    s_add_u32 s80, s80, 1
    s_add_u32 s81, s81, s65
    v_add_f32_dpp v22, v22, v22 row_ror:4 row_mask:0xf bank_mask:0xf
    s_cmp_eq_u32 s80, s72
    s_nop 0
    v_add_f32_dpp v22, v22, v22 row_ror:8 row_mask:0xf bank_mask:0xf
    v_max_f32 v22, v23, v22
    v_rsq_f32 v22, v22
    s_nop 1
    v_fmac_f32_dpp v96, v22, v92 quad_perm:[0,0,0,0] row_mask:0xf bank_mask:0xf
    v_fmac_f32_dpp v97, v22, v93 quad_perm:[1,1,1,1] row_mask:0xf bank_mask:0xf
    v_fmac_f32_dpp v98, v22, v94 quad_perm:[2,2,2,2] row_mask:0xf bank_mask:0xf
    v_fmac_f32_dpp v99, v22, v95 quad_perm:[3,3,3,3] row_mask:0xf bank_mask:0xf
L_cback:
    v_exp_f32 v88, v96
    v_exp_f32 v89, v97
    v_exp_f32 v90, v98
    v_exp_f32 v91, v99
    v_add_f32 v86, v88, v89
    v_add_f32 v87, v90, v91
    v_mul_f32_dpp v6, v22, v88 quad_perm:[0,0,0,0] row_mask:0xf bank_mask:0xf
    v_mul_f32_dpp v7, v22, v89 quad_perm:[1,1,1,1] row_mask:0xf bank_mask:0xf
    v_add_f32 v88, v86, v87
    v_cmp_nge_f32 vcc, s69, v88
    v_mul_f32_dpp v8, v22, v90 quad_perm:[2,2,2,2] row_mask:0xf bank_mask:0xf
    v_mul_f32_dpp v9, v22, v91 quad_perm:[3,3,3,3] row_mask:0xf bank_mask:0xf
    v_cvt_pk_bf16_f32 v84, v6, v7
    v_cvt_pk_bf16_f32 v85, v8, v9
    v_mov_b32 v86, v84
    v_mov_b32 v87, v85
    s_waitcnt lgkmcnt(0)
    s_cbranch_vccnz L_cslow
L_cgo:
    v_mfma_f32_16x16x32_bf16 v[100:103], v[124:127], v[84:87], v[100:103]
    v_add_f32 v25, v25, v88
    s_cbranch_scc0 L_cmore
    v_mfma_f32_16x16x32_bf16 v[104:107], v[128:131], v[84:87], v[104:107]
    ds_write_b64 v26, v[24:25] offset:24576
    v_mfma_f32_16x16x32_bf16 v[108:111], v[132:135], v[84:87], v[108:111]
    v_mfma_f32_16x16x32_bf16 v[112:115], v[136:139], v[84:87], v[112:115]
    v_mfma_f32_16x16x32_bf16 v[116:119], v[140:143], v[84:87], v[116:119]
    s_nop 0
    v_cvt_pk_bf16_f32 v40, v100, v101
    v_cvt_pk_bf16_f32 v41, v102, v103
    v_mfma_f32_16x16x32_bf16 v[120:123], v[144:147], v[84:87], v[120:123]
    v_cvt_pk_bf16_f32 v42, v104, v105
    v_cvt_pk_bf16_f32 v43, v106, v107
    ds_write_b128 v26, v[40:43]
    v_cvt_pk_bf16_f32 v44, v108, v109
    v_cvt_pk_bf16_f32 v45, v110, v111
    v_cvt_pk_bf16_f32 v46, v112, v113
    v_cvt_pk_bf16_f32 v47, v114, v115
    ds_write_b128 v26, v[44:47] offset:1024
    v_cvt_pk_bf16_f32 v48, v116, v117
    v_cvt_pk_bf16_f32 v49, v118, v119
    v_cvt_pk_bf16_f32 v50, v120, v121
    v_cvt_pk_bf16_f32 v51, v122, v123
    ds_write_b128 v26, v[48:51] offset:2048
    ds_write_b32 v27, v148 offset:6784
    s_branch L_cons
L_pad5:
    s_branch L_padret
L_cmore:
    s_bitcmp1_b32 s80, 0
    v_mfma_f32_16x16x32_bf16 v[104:107], v[128:131], v[84:87], v[104:107]
    v_mfma_f32_16x16x32_bf16 v[108:111], v[132:135], v[84:87], v[108:111]
    v_mfma_f32_16x16x32_bf16 v[112:115], v[136:139], v[84:87], v[112:115]
    v_mfma_f32_16x16x32_bf16 v[116:119], v[140:143], v[84:87], v[116:119]
    v_mfma_f32_16x16x32_bf16 v[120:123], v[144:147], v[84:87], v[120:123]
    s_cbranch_scc1 L_ctile
    s_add_u32 s73, s83, 10
    s_cmp_eq_u32 s65, 8
    s_cbranch_scc1 L_cpre2
    s_add_u32 s73, s83, 2
    s_add_u32 s81, s83, 4
    s_mov_b32 s65, 8
    s_branch L_cpre
L_tl11:
    s_add_u32 s82, s82, 1
    s_cmp_gt_u32 s82, 4194304
    s_cbranch_scc1 L_end
    s_cmp_lg_u32 s66, 0
    s_cbranch_scc1 L_tl11_in
    s_mov_b32 s66, 1
    s_branch L_w12_in
L_w12:
    s_sleep 2
L_w12_in:
    ds_read_b32 v6, v5 offset:6752
    s_add_u32 s82, s82, 1
    s_cmp_gt_u32 s82, 4194304
    s_cbranch_scc1 L_end
    s_waitcnt lgkmcnt(0)
    v_cmp_gt_i32 vcc, s81, v6
    s_cbranch_vccnz L_w12
    s_branch L_tl11_in
L_cslow:
    s_cmp_lg_u32 s66, 2
    s_cbranch_scc1 L_cslow1
    s_cmp_eq_u32 s80, s72
    s_branch L_cgo
L_cslow1:
    s_mov_b32 s66, 2
    v_max_f32 v8, v96, v97
    v_max3_f32 v8, v8, v98, v99
    s_cmp_lg_u32 s80, 1
    s_cbranch_scc1 L_craise
    v_lshl_add_u32 v9, v3, 4, v19
    v_mov_b32 v96, 0
    v_mov_b32 v97, 0
    v_mov_b32 v98, 0
    v_mov_b32 v99, 0
    s_cmp_lt_u32 s3, 3
    s_cbranch_scc1 L_cnoredo
    s_branch L_w13_in
L_w13:
    s_sleep 1
L_w13_in:
    ds_read_b128 v[84:87], v5 offset:6688
    ds_read_b128 v[28:31], v9 offset:0
    ds_read_b128 v[32:35], v9 offset:64
    ds_read_b128 v[36:39], v9 offset:128
    s_add_u32 s82, s82, 1
    s_cmp_gt_u32 s82, 4194304
    s_cbranch_scc1 L_end
    s_waitcnt lgkmcnt(3)
    v_min3_u32 v84, v84, v85, v86
    v_cmp_eq_u32 vcc, 0, v84
    s_cbranch_vccnz L_w13
    s_waitcnt lgkmcnt(0)
    v_mfma_f32_16x16x32_bf16 v[80:83], v[40:43], v[28:31], 0
    v_mfma_f32_16x16x32_bf16 v[80:83], v[44:47], v[32:35], v[80:83]
    v_mfma_f32_16x16x32_bf16 v[80:83], v[48:51], v[36:39], v[80:83]
    v_mfma_f32_16x16x32_bf16 v[92:95], v[64:67], v[28:31], v[80:83]
    v_mfma_f32_16x16x32_bf16 v[92:95], v[68:71], v[32:35], v[92:95]
    v_mfma_f32_16x16x32_bf16 v[92:95], v[72:75], v[36:39], v[92:95]
    s_nop 7
L_cnoredo:
    v_fmac_f32_dpp v96, v22, v92 quad_perm:[0,0,0,0] row_mask:0xf bank_mask:0xf
    v_fmac_f32_dpp v97, v22, v93 quad_perm:[1,1,1,1] row_mask:0xf bank_mask:0xf
    v_fmac_f32_dpp v98, v22, v94 quad_perm:[2,2,2,2] row_mask:0xf bank_mask:0xf
    v_fmac_f32_dpp v99, v22, v95 quad_perm:[3,3,3,3] row_mask:0xf bank_mask:0xf
    v_max_f32 v8, v96, v97
    v_max3_f32 v8, v8, v98, v99
    s_cmp_eq_u32 s83, 3
    s_cbranch_scc0 L_cref
    v_mov_b32 v6, v8
    v_mov_b32 v24, v8
    s_nop 1
    v_permlane32_swap_b32 v24, v6
    v_max_f32 v24, v24, v6
    v_mov_b32 v6, v24
    s_nop 1
    v_permlane16_swap_b32 v24, v6
    v_max_f32 v24, v24, v6
    v_add_f32 v24, 0x41800000, v24
    ds_write_b32 v19, v24 offset:204
    ds_write_b32 v5, v148 offset:6772
L_cref:
L_w14:
    ds_read_b32 v6, v5 offset:6772
    ds_read_b32 v24, v19 offset:204
    s_add_u32 s82, s82, 1
    s_cmp_gt_u32 s82, 4194304
    s_cbranch_scc1 L_end
    s_waitcnt lgkmcnt(0)
    v_cmp_eq_u32 vcc, 0, v6
    s_cbranch_vccnz L_w14
    v_sub_f32 v96, v96, v24
    v_sub_f32 v97, v97, v24
    v_sub_f32 v98, v98, v24
    v_sub_f32 v99, v99, v24
    v_sub_f32 v8, v8, v24
    v_cmp_nge_f32 vcc, s64, v8
    s_cmp_eq_u32 s80, s72
    s_cbranch_vccz L_cback
L_craise:
    v_mov_b32 v6, v8
    s_nop 1
    v_permlane32_swap_b32 v8, v6
    v_max_f32 v8, v8, v6
    v_mov_b32 v6, v8
    s_nop 1
    v_permlane16_swap_b32 v8, v6
    v_max_f32 v8, v8, v6
    v_max_f32 v8, 0, v8
    v_add_f32 v9, v24, v8
    v_sub_f32 v8, v24, v9
    v_mov_b32 v24, v9
    v_exp_f32 v6, v8
    v_add_f32 v96, v96, v8
    v_add_f32 v97, v97, v8
    v_add_f32 v98, v98, v8
    v_add_f32 v99, v99, v8
    v_mul_f32 v25, v25, v6
    v_mul_f32 v100, v100, v6
    v_mul_f32 v101, v101, v6
    v_mul_f32 v102, v102, v6
    v_mul_f32 v103, v103, v6
    v_mul_f32 v104, v104, v6
    v_mul_f32 v105, v105, v6
    v_mul_f32 v106, v106, v6
    v_mul_f32 v107, v107, v6
    v_mul_f32 v108, v108, v6
    v_mul_f32 v109, v109, v6
    v_mul_f32 v110, v110, v6
    v_mul_f32 v111, v111, v6
    v_mul_f32 v112, v112, v6
    v_mul_f32 v113, v113, v6
    v_mul_f32 v114, v114, v6
    v_mul_f32 v115, v115, v6
    v_mul_f32 v116, v116, v6
    v_mul_f32 v117, v117, v6
    v_mul_f32 v118, v118, v6
    v_mul_f32 v119, v119, v6
    v_mul_f32 v120, v120, v6
    v_mul_f32 v121, v121, v6
    v_mul_f32 v122, v122, v6
    v_mul_f32 v123, v123, v6
    v_mov_b32 v148, 3
    s_cmp_eq_u32 s80, s72
    s_branch L_cback
L_pad10:
    s_branch L_padret
L_cons:
    s_cmp_ge_u32 s2, 96
    s_cbranch_scc1 L_fin
    s_setprio 0
    s_mov_b32 s60, s30
    s_and_b32 s61, s31, 0xffff
    s_mov_b32 s62, 3072
    s_mov_b32 s63, 0x00020000
    s_mul_i32 s79, s78, 0x9E3779B1
    s_add_u32 s79, s79, 0x7F4A7C15
    s_mul_i32 s70, s2, 16384
    s_lshl_b32 s71, s83, 11
    v_mov_b32 v50, v4
    s_add_u32 s67, s70, s71
    s_lshl_b32 s68, s2, 5
    v_lshlrev_b32 v10, 1, v2
    buffer_load_ushort v11, v10, s[44:47], s68 offen
    v_and_b32 v44, 3, v1
    v_lshlrev_b32 v44, 4, v44
    v_and_b32 v45, 1, v3
    v_lshl_add_u32 v44, v45, 3, v44
    v_lshrrev_b32 v45, 1, v3
    v_lshl_add_u32 v44, v45, 2, v44
    s_lshl_b32 s70, s83, 6
    v_add_u32 v44, s70, v44
    s_lshl_b32 s70, s83, 5
    v_lshl_add_u32 v45, v3, 3, s70
    v_mov_b32 v46, 1
    v_lshlrev_b32 v47, 2, v1
    v_and_b32 v48, 31, v1
    v_lshlrev_b32 v48, 3, v48
    v_lshlrev_b32 v49, 5, v3
    v_add_u32 v49, 26112, v49
    v_mov_b32 v30, v1
    v_mov_b32 v34, v1
    s_branch L_w15_in
L_w15:
    s_sleep 2
L_w15_in:
    ds_read_b128 v[40:43], v5 offset:6736
    s_add_u32 s82, s82, 1
    s_cmp_gt_u32 s82, 4194304
    s_cbranch_scc1 L_end
    s_waitcnt lgkmcnt(0)
    v_min3_u32 v40, v40, v41, v42
    v_cmp_eq_u32 vcc, 0, v40
    s_cbranch_vccnz L_w15
    s_waitcnt vmcnt(0)
    s_mov_b64 vcc, -1
L_poll16:
    s_mov_b64 exec, vcc
    buffer_load_dwordx4 v[28:31], v50, s[56:59], s67 offen sc1
    buffer_load_dwordx4 v[32:35], v50, s[56:59], s67 offen offset:1024 sc1
    s_mov_b64 exec, -1
    s_add_u32 s82, s82, 1
    s_cmp_gt_u32 s82, 4194304
    s_cbranch_scc1 L_end
    s_waitcnt vmcnt(0)
    v_bitop3_b32 v6, v28, v29, v30 bitop3:0x96
    v_bitop3_b32 v7, v32, v33, v34 bitop3:0x96
    v_max_f32 v12, v30, v34
    v_bitop3_b32 v6, v6, v31, s79 bitop3:0x96
    v_bitop3_b32 v7, v7, v35, s79 bitop3:0x96
    v_max_f32_dpp v12, v12, v12 row_ror:4 row_mask:0xf bank_mask:0xf
    v_xor_b32_dpp v8, v30, v30 quad_perm:[1,2,3,0] row_mask:0xf bank_mask:0xf
    v_xor_b32_dpp v9, v34, v34 quad_perm:[1,2,3,0] row_mask:0xf bank_mask:0xf
    v_max_f32_dpp v12, v12, v12 row_ror:8 row_mask:0xf bank_mask:0xf
    v_or3_b32 v6, v6, v7, v8
    v_mov_b32 v13, v12
    v_or_b32 v6, v6, v9
    v_cmp_ne_u32 vcc, 0, v6
    v_permlane32_swap_b32 v12, v13
    v_max_f32 v12, v12, v13
    v_mov_b32 v13, v12
    v_lshlrev_b32 v16, 16, v28
    v_and_b32 v17, 0xffff0000, v28
    v_permlane16_swap_b32 v12, v13
    v_max_f32 v12, v12, v13
    v_sub_f32 v14, v30, v12
    s_cbranch_vccnz L_poll16
    v_sub_f32 v15, v34, v12
    v_exp_f32 v14, v14
    v_exp_f32 v15, v15
    v_lshlrev_b32 v20, 16, v32
    v_and_b32 v21, 0xffff0000, v32
    v_add_f32 v13, v14, v15
    v_mul_f32 v36, v14, v16
    v_mul_f32 v37, v14, v17
    v_add_f32_dpp v13, v13, v13 row_ror:4 row_mask:0xf bank_mask:0xf
    v_fmac_f32 v36, v15, v20
    v_fmac_f32 v37, v15, v21
    v_add_f32_dpp v13, v13, v13 row_ror:8 row_mask:0xf bank_mask:0xf
    v_lshlrev_b32 v18, 16, v29
    v_and_b32 v19, 0xffff0000, v29
    v_permlane32_swap_b32 v36, v37
    v_lshlrev_b32 v22, 16, v33
    v_and_b32 v23, 0xffff0000, v33
    v_mul_f32 v38, v14, v18
    v_mul_f32 v39, v14, v19
    v_fmac_f32 v38, v15, v22
    v_fmac_f32 v39, v15, v23
    v_add_f32 v36, v36, v37
    ds_write_b64 v45, v[12:13] offset:26112
    v_permlane32_swap_b32 v38, v39
    v_add_f32 v38, v38, v39
    s_nop 1
    v_permlane16_swap_b32 v36, v38
    v_add_f32 v36, v36, v38
    s_nop 1
    v_add_f32_dpp v36, v36, v36 row_ror:4 row_mask:0xf bank_mask:0xf
    s_nop 1
    v_add_f32_dpp v36, v36, v36 row_ror:8 row_mask:0xf bank_mask:0xf
    ds_write_b32 v44, v36 offset:25600
    s_mov_b64 exec, 1
    ds_add_rtn_u32 v9, v5, v46 offset:6756
    s_mov_b64 exec, -1
    ds_read_b64 v[18:19], v48 offset:26112
    ds_read2_b32 v[20:21], v49 offset0:0 offset1:32
    ds_read2st64_b32 v[16:17], v47 offset0:100 offset1:101
    s_waitcnt lgkmcnt(2)
    v_readfirstlane_b32 s70, v9
    v_max_f32_dpp v12, v18, v18 row_ror:4 row_mask:0xf bank_mask:0xf
    s_cmp_lg_u32 s70, 7
    s_cbranch_scc1 L_fin
    v_max_f32_dpp v12, v12, v12 row_ror:8 row_mask:0xf bank_mask:0xf
    v_lshlrev_b32 v11, 16, v11
    v_mov_b32 v13, v12
    s_nop 1
    v_permlane16_swap_b32 v12, v13
    v_max_f32 v12, v12, v13
    s_waitcnt lgkmcnt(0)
    v_sub_f32 v18, v18, v12
    v_sub_f32 v20, v20, v12
    v_sub_f32 v21, v21, v12
    v_exp_f32 v18, v18
    v_exp_f32 v20, v20
    v_exp_f32 v21, v21
    v_mul_f32 v19, v19, v18
    v_mul_f32 v16, v16, v20
    v_fmac_f32 v16, v17, v21
    v_add_f32_dpp v19, v19, v19 quad_perm:[1,0,3,2] row_mask:0xf bank_mask:0xf
    v_mov_b32 v13, v16
    s_nop 0
    v_add_f32_dpp v19, v19, v19 quad_perm:[2,3,0,1] row_mask:0xf bank_mask:0xf
    v_permlane32_swap_b32 v16, v13
    v_add_f32 v16, v16, v13
    v_add_f32_dpp v19, v19, v19 row_ror:4 row_mask:0xf bank_mask:0xf
    v_mov_b32 v13, v16
    s_nop 0
    v_add_f32_dpp v19, v19, v19 row_ror:8 row_mask:0xf bank_mask:0xf
    v_permlane16_swap_b32 v16, v13
    v_mov_b32 v14, v19
    v_add_f32 v16, v16, v13
    s_nop 0
    v_permlane16_swap_b32 v19, v14
    v_add_f32 v19, v19, v14
    v_rcp_f32 v19, v19
    s_mov_b64 exec, 0xffff
    v_fma_f32 v16, v16, v19, v11
    v_cvt_pk_bf16_f32 v16, v16, v16
    buffer_store_short v16, v10, s[60:63], s68 offen
    s_cmp_lg_u32 s2, 0
    s_cbranch_scc1 L_fin
    s_add_u32 s78, s78, 1
    v_mov_b32 v6, s78
    v_mov_b32 v7, 4194304
    s_mov_b64 exec, 1
    buffer_store_dword v6, v7, s[56:59], 0 offen
    s_branch L_fin
L_pad11:
    s_branch L_padret
L_finisher:
    s_sub_u32 s4, s4, 12
    s_setprio 1
    s_mov_b32 s56, s34
    s_and_b32 s57, s35, 0xffff
    s_mov_b32 s58, 268435456
    s_mov_b32 s59, 0x00020000
    s_add_u32 s6, s34, 4194304
    s_addc_u32 s7, s35, 0
    s_load_dword s78, s[6:7], 0
    v_lshrrev_b32 v6, 2, v2
    v_lshl_add_u32 v6, v3, 3, v6
    v_and_b32 v7, 3, v1
    v_mul_u32_u24 v12, 192, v6
    v_lshl_add_u32 v12, v7, 3, v12
    s_lshl_b32 s70, s4, 6
    s_add_u32 s70, s70, 145408
    v_add_u32 v12, s70, v12
    v_lshrrev_b32 v6, 1, v2
    v_and_b32 v6, 2, v6
    v_xor_b32 v6, v6, v3
    v_mul_u32_u24 v10, 192, v2
    v_lshl_add_u32 v10, v6, 4, v10
    v_mov_b32 v16, 1
    s_lshl_b32 s70, s4, 2
    v_mov_b32 v17, s70
    s_lshl_b32 s70, s4, 10
    v_add_u32 v13, s70, v4
    v_add_u32 v18, 114688, v13
    v_add_u32 v11, 139264, v4
    s_and_b32 s70, s2, 7
    s_lshl_b32 s70, s70, 5
    s_lshr_b32 s71, s2, 3
    s_add_u32 s70, s70, s71
    s_lshl_b32 s70, s70, 6
    s_mul_i32 s71, s4, 32768
    s_add_u32 s68, s70, s71
    s_add_u32 s69, s68, 16384
    v_mul_u32_u24 v50, 98304, v2
    v_lshl_add_u32 v50, v3, 4, v50
    s_lshr_b32 s71, s2, 3
    s_mul_i32 s70, s4, 0
    s_add_u32 s70, s70, s71
    v_mul_u32_u24 v6, 2, v2
    v_add_u32 v6, s70, v6
    v_and_b32 v6, 31, v6
    v_lshl_add_u32 v50, v6, 6, v50
    s_lshl_b32 s71, s71, 6
    s_sub_u32 s68, s68, s71
    s_sub_u32 s69, s69, s71
    s_branch L_w17_in
L_w17:
    s_sleep 4
L_w17_in:
    ds_read_b32 v6, v5 offset:6768
    s_add_u32 s82, s82, 1
    s_cmp_gt_u32 s82, 4194304
    s_cbranch_scc1 L_end
    s_waitcnt lgkmcnt(0)
    v_cmp_eq_u32 vcc, 0, v6
    s_cbranch_vccnz L_w17
    ds_read_b64_tr_b16 v[64:65], v12 offset:0
    ds_read_b64_tr_b16 v[66:67], v12 offset:768
    ds_read_b64_tr_b16 v[68:69], v12 offset:6144
    ds_read_b64_tr_b16 v[70:71], v12 offset:6912
    ds_read_b64_tr_b16 v[72:73], v12 offset:12288
    ds_read_b64_tr_b16 v[74:75], v12 offset:13056
    ds_read_b64_tr_b16 v[76:77], v12 offset:32
    ds_read_b64_tr_b16 v[78:79], v12 offset:800
    ds_read_b64_tr_b16 v[80:81], v12 offset:6176
    ds_read_b64_tr_b16 v[82:83], v12 offset:6944
    ds_read_b64_tr_b16 v[84:85], v12 offset:12320
    ds_read_b64_tr_b16 v[86:87], v12 offset:13088
    s_mul_i32 s79, s78, 0x9E3779B1
    s_add_u32 s79, s79, 0x7F4A7C15
    buffer_load_dword v51, v50, s[56:59], s68 offen sc1
    buffer_load_dword v51, v50, s[56:59], s69 offen sc1
    s_waitcnt lgkmcnt(0)
    ds_write_b32 v17, v16 offset:6704
    s_branch L_w18_in
L_pad12:
    s_branch L_padret
L_w18:
    s_sleep 2
L_w18_in:
    ds_read_b32 v6, v5 offset:6764
    s_add_u32 s82, s82, 1
    s_cmp_gt_u32 s82, 4194304
    s_cbranch_scc1 L_end
    s_waitcnt lgkmcnt(0)
    v_cmp_eq_u32 vcc, 0, v6
    s_cbranch_vccnz L_w18
    ds_read_b128 v[88:91], v10 offset:7168
    ds_read_b128 v[92:95], v10 offset:7232
    ds_read_b128 v[96:99], v10 offset:7296
    ds_read_b128 v[52:55], v10 offset:10240
    ds_read_b128 v[56:59], v10 offset:10304
    ds_read_b128 v[60:63], v10 offset:10368
    s_waitcnt lgkmcnt(3)
    v_mfma_f32_16x16x32_bf16 v[100:103], v[88:91], v[64:67], 0
    v_mfma_f32_16x16x32_bf16 v[124:127], v[88:91], v[76:79], 0
    v_mfma_f32_16x16x32_bf16 v[100:103], v[92:95], v[68:71], v[100:103]
    v_mfma_f32_16x16x32_bf16 v[124:127], v[92:95], v[80:83], v[124:127]
    v_mfma_f32_16x16x32_bf16 v[100:103], v[96:99], v[72:75], v[100:103]
    v_mfma_f32_16x16x32_bf16 v[124:127], v[96:99], v[84:87], v[124:127]
    ds_read_b128 v[88:91], v10 offset:13312
    ds_read_b128 v[92:95], v10 offset:13376
    ds_read_b128 v[96:99], v10 offset:13440
    s_waitcnt lgkmcnt(3)
    v_mfma_f32_16x16x32_bf16 v[104:107], v[52:55], v[64:67], 0
    v_mfma_f32_16x16x32_bf16 v[128:131], v[52:55], v[76:79], 0
    v_mfma_f32_16x16x32_bf16 v[104:107], v[56:59], v[68:71], v[104:107]
    v_mfma_f32_16x16x32_bf16 v[128:131], v[56:59], v[80:83], v[128:131]
    v_mfma_f32_16x16x32_bf16 v[104:107], v[60:63], v[72:75], v[104:107]
    v_mfma_f32_16x16x32_bf16 v[128:131], v[60:63], v[84:87], v[128:131]
    ds_read_b128 v[52:55], v10 offset:16384
    ds_read_b128 v[56:59], v10 offset:16448
    ds_read_b128 v[60:63], v10 offset:16512
    s_waitcnt lgkmcnt(3)
    v_mfma_f32_16x16x32_bf16 v[108:111], v[88:91], v[64:67], 0
    v_mfma_f32_16x16x32_bf16 v[132:135], v[88:91], v[76:79], 0
    v_mfma_f32_16x16x32_bf16 v[108:111], v[92:95], v[68:71], v[108:111]
    v_mfma_f32_16x16x32_bf16 v[132:135], v[92:95], v[80:83], v[132:135]
    v_mfma_f32_16x16x32_bf16 v[108:111], v[96:99], v[72:75], v[108:111]
    v_mfma_f32_16x16x32_bf16 v[132:135], v[96:99], v[84:87], v[132:135]
    ds_read_b128 v[88:91], v10 offset:19456
    ds_read_b128 v[92:95], v10 offset:19520
    ds_read_b128 v[96:99], v10 offset:19584
    s_waitcnt lgkmcnt(3)
    v_mfma_f32_16x16x32_bf16 v[112:115], v[52:55], v[64:67], 0
    v_mfma_f32_16x16x32_bf16 v[136:139], v[52:55], v[76:79], 0
    v_mfma_f32_16x16x32_bf16 v[112:115], v[56:59], v[68:71], v[112:115]
    v_mfma_f32_16x16x32_bf16 v[136:139], v[56:59], v[80:83], v[136:139]
    v_mfma_f32_16x16x32_bf16 v[112:115], v[60:63], v[72:75], v[112:115]
    v_mfma_f32_16x16x32_bf16 v[136:139], v[60:63], v[84:87], v[136:139]
    ds_read_b128 v[52:55], v10 offset:22528
    ds_read_b128 v[56:59], v10 offset:22592
    ds_read_b128 v[60:63], v10 offset:22656
    s_waitcnt lgkmcnt(3)
    v_mfma_f32_16x16x32_bf16 v[116:119], v[88:91], v[64:67], 0
    v_mfma_f32_16x16x32_bf16 v[140:143], v[88:91], v[76:79], 0
    v_mfma_f32_16x16x32_bf16 v[116:119], v[92:95], v[68:71], v[116:119]
    v_mfma_f32_16x16x32_bf16 v[140:143], v[92:95], v[80:83], v[140:143]
    v_mfma_f32_16x16x32_bf16 v[116:119], v[96:99], v[72:75], v[116:119]
    v_mfma_f32_16x16x32_bf16 v[140:143], v[96:99], v[84:87], v[140:143]
    s_waitcnt lgkmcnt(0)
    v_mfma_f32_16x16x32_bf16 v[120:123], v[52:55], v[64:67], 0
    v_mfma_f32_16x16x32_bf16 v[144:147], v[52:55], v[76:79], 0
    v_mfma_f32_16x16x32_bf16 v[120:123], v[56:59], v[68:71], v[120:123]
    v_mfma_f32_16x16x32_bf16 v[144:147], v[56:59], v[80:83], v[144:147]
    v_mfma_f32_16x16x32_bf16 v[120:123], v[60:63], v[72:75], v[120:123]
    v_mfma_f32_16x16x32_bf16 v[144:147], v[60:63], v[84:87], v[144:147]
    v_add_f32 v8, v100, v101
    v_add_f32 v8, v8, v102
    v_add_f32 v8, v8, v103
    v_add_f32 v8, v8, v104
    v_add_f32 v8, v8, v105
    v_add_f32 v8, v8, v106
    v_add_f32 v8, v8, v107
    v_add_f32 v8, v8, v108
    v_add_f32 v8, v8, v109
    v_add_f32 v8, v8, v110
    v_add_f32 v8, v8, v111
    v_add_f32 v8, v8, v112
    v_add_f32 v8, v8, v113
    v_add_f32 v8, v8, v114
    v_add_f32 v8, v8, v115
    v_add_f32 v8, v8, v116
    v_add_f32 v8, v8, v117
    v_add_f32 v8, v8, v118
    v_add_f32 v8, v8, v119
    v_add_f32 v8, v8, v120
    v_add_f32 v8, v8, v121
    v_add_f32 v8, v8, v122
    v_add_f32 v8, v8, v123
    v_mov_b32 v6, v8
    s_nop 1
    v_permlane32_swap_b32 v8, v6
    v_add_f32 v8, v8, v6
    v_mov_b32 v6, v8
    s_nop 1
    v_permlane16_swap_b32 v8, v6
    v_add_f32 v8, v8, v6
    v_mul_f32 v8, 0xbc2aaaab, v8
    v_add_f32 v100, v100, v8
    v_add_f32 v101, v101, v8
    v_add_f32 v102, v102, v8
    v_add_f32 v103, v103, v8
    v_add_f32 v104, v104, v8
    v_add_f32 v105, v105, v8
    v_add_f32 v106, v106, v8
    v_add_f32 v107, v107, v8
    v_add_f32 v108, v108, v8
    v_add_f32 v109, v109, v8
    v_add_f32 v110, v110, v8
    v_add_f32 v111, v111, v8
    v_add_f32 v112, v112, v8
    v_add_f32 v113, v113, v8
    v_add_f32 v114, v114, v8
    v_add_f32 v115, v115, v8
    v_add_f32 v116, v116, v8
    v_add_f32 v117, v117, v8
    v_add_f32 v118, v118, v8
    v_add_f32 v119, v119, v8
    v_add_f32 v120, v120, v8
    v_add_f32 v121, v121, v8
    v_add_f32 v122, v122, v8
    v_add_f32 v123, v123, v8
    v_cvt_pk_bf16_f32 v64, v100, v101
    v_cvt_pk_bf16_f32 v65, v102, v103
    v_cvt_pk_bf16_f32 v66, v104, v105
    v_cvt_pk_bf16_f32 v67, v106, v107
    v_cvt_pk_bf16_f32 v68, v108, v109
    v_cvt_pk_bf16_f32 v69, v110, v111
    v_cvt_pk_bf16_f32 v70, v112, v113
    v_cvt_pk_bf16_f32 v71, v114, v115
    v_cvt_pk_bf16_f32 v72, v116, v117
    v_cvt_pk_bf16_f32 v73, v118, v119
    v_cvt_pk_bf16_f32 v74, v120, v121
    v_cvt_pk_bf16_f32 v75, v122, v123
    v_add_f32 v9, v124, v125
    v_add_f32 v9, v9, v126
    v_add_f32 v9, v9, v127
    v_add_f32 v9, v9, v128
    v_add_f32 v9, v9, v129
    v_add_f32 v9, v9, v130
    v_add_f32 v9, v9, v131
    v_add_f32 v9, v9, v132
    v_add_f32 v9, v9, v133
    v_add_f32 v9, v9, v134
    v_add_f32 v9, v9, v135
    v_add_f32 v9, v9, v136
    v_add_f32 v9, v9, v137
    v_add_f32 v9, v9, v138
    v_add_f32 v9, v9, v139
    v_add_f32 v9, v9, v140
    s_branch L_pads14
L_pad13:
    s_branch L_padret
L_pads14:
    v_add_f32 v9, v9, v141
    v_add_f32 v9, v9, v142
    v_add_f32 v9, v9, v143
    v_add_f32 v9, v9, v144
    v_add_f32 v9, v9, v145
    v_add_f32 v9, v9, v146
    v_add_f32 v9, v9, v147
    v_mov_b32 v6, v9
    s_nop 1
    v_permlane32_swap_b32 v9, v6
    v_add_f32 v9, v9, v6
    v_mov_b32 v6, v9
    s_nop 1
    v_permlane16_swap_b32 v9, v6
    v_add_f32 v9, v9, v6
    v_mul_f32 v9, 0xbc2aaaab, v9
    v_add_f32 v124, v124, v9
    v_add_f32 v125, v125, v9
    v_add_f32 v126, v126, v9
    v_add_f32 v127, v127, v9
    v_add_f32 v128, v128, v9
    v_add_f32 v129, v129, v9
    v_add_f32 v130, v130, v9
    v_add_f32 v131, v131, v9
    v_add_f32 v132, v132, v9
    v_add_f32 v133, v133, v9
    v_add_f32 v134, v134, v9
    v_add_f32 v135, v135, v9
    v_add_f32 v136, v136, v9
    v_add_f32 v137, v137, v9
    v_add_f32 v138, v138, v9
    v_add_f32 v139, v139, v9
    v_add_f32 v140, v140, v9
    v_add_f32 v141, v141, v9
    v_add_f32 v142, v142, v9
    v_add_f32 v143, v143, v9
    v_add_f32 v144, v144, v9
    v_add_f32 v145, v145, v9
    v_add_f32 v146, v146, v9
    v_add_f32 v147, v147, v9
    v_cvt_pk_bf16_f32 v76, v124, v125
    v_cvt_pk_bf16_f32 v77, v126, v127
    v_cvt_pk_bf16_f32 v78, v128, v129
    v_cvt_pk_bf16_f32 v79, v130, v131
    v_cvt_pk_bf16_f32 v80, v132, v133
    v_cvt_pk_bf16_f32 v81, v134, v135
    v_cvt_pk_bf16_f32 v82, v136, v137
    v_cvt_pk_bf16_f32 v83, v138, v139
    v_cvt_pk_bf16_f32 v84, v140, v141
    v_cvt_pk_bf16_f32 v85, v142, v143
    s_branch L_pads15
L_pad14:
    s_branch L_padret
L_pads15:
    v_cvt_pk_bf16_f32 v86, v144, v145
    v_cvt_pk_bf16_f32 v87, v146, v147
    v_lshrrev_b32 v6, 2, v2
    v_cmp_eq_u32 vcc, v6, v3
    v_and_b32 v7, 1, v1
    v_lshlrev_b32 v7, 4, v7
    v_mov_b32 v8, 0x3f80
    v_lshlrev_b32 v8, v7, v8
    v_cndmask_b32 v8, 0, v8, vcc
    v_and_b32 v7, 2, v1
    v_cmp_eq_u32 vcc, 0, v7
    v_mov_b32 v88, 0
    v_mov_b32 v89, 0
    v_cndmask_b32 v90, 0, v8, vcc
    v_cndmask_b32 v91, v8, 0, vcc
    v_mov_b32 v92, 0
    v_mov_b32 v93, 0
    v_mul_u32_u24 v8, 208, v2
    s_branch L_w19_in
L_w19:
    s_sleep 1
L_w19_in:
    ds_read_b32 v6, v5 offset:6772
    ds_read_b32 v14, v8 offset:204
    s_add_u32 s82, s82, 1
    s_cmp_gt_u32 s82, 4194304
    s_cbranch_scc1 L_end
    s_waitcnt lgkmcnt(0)
    v_cmp_eq_u32 vcc, 0, v6
    s_cbranch_vccnz L_w19
    v_mov_b32 v15, 0
    s_mov_b32 s80, 2
    v_mov_b32 v28, 0
    v_mov_b32 v29, 0
    v_mov_b32 v30, 0
    v_mov_b32 v31, 0
    v_mov_b32 v32, 0
    v_mov_b32 v33, 0
    v_mov_b32 v34, 0
    v_mov_b32 v35, 0
    s_branch L_w20_in
L_pad15:
    s_branch L_padret
L_w20:
    s_sleep 1
L_w20_in:
    ds_read_b32 v6, v5 offset:6784
    s_add_u32 s82, s82, 1
    s_cmp_gt_u32 s82, 4194304
    s_cbranch_scc1 L_end
    s_waitcnt lgkmcnt(0)
    v_cmp_eq_u32 vcc, 0, v6
    s_cbranch_vccnz L_w20
    s_setprio 1
    ds_read_b32 v106, v5 offset:6784
    ds_read_b128 v[100:103], v18 offset:0
    ds_read_b64 v[104:105], v11 offset:0
L_fchk0:
    s_waitcnt lgkmcnt(2)
    v_cmp_ne_u32 vcc, s80, v106
    ds_read_b32 v114, v5 offset:6788
    ds_read_b128 v[108:111], v18 offset:3072
    ds_read_b64 v[112:113], v11 offset:3072
    s_cbranch_vccnz L_fretry0
    s_waitcnt lgkmcnt(3)
    v_mfma_f32_16x16x32_bf16 v[28:31], v[90:93], v[100:103], v[28:31]
    v_mfma_f32_16x16x32_bf16 v[32:35], v[88:91], v[100:103], v[32:35]
    v_add_f32 v15, v15, v105
L_fnext0:
L_fchk1:
    s_waitcnt lgkmcnt(2)
    v_cmp_ne_u32 vcc, s80, v114
    ds_read_b32 v106, v5 offset:6792
    ds_read_b128 v[100:103], v18 offset:6144
    ds_read_b64 v[104:105], v11 offset:6144
    s_cbranch_vccnz L_fretry1
    s_waitcnt lgkmcnt(3)
    v_mfma_f32_16x16x32_bf16 v[28:31], v[90:93], v[108:111], v[28:31]
    v_mfma_f32_16x16x32_bf16 v[32:35], v[88:91], v[108:111], v[32:35]
    v_add_f32 v15, v15, v113
L_fnext1:
L_fchk2:
    s_waitcnt lgkmcnt(2)
    v_cmp_ne_u32 vcc, s80, v106
    ds_read_b32 v114, v5 offset:6796
    ds_read_b128 v[108:111], v18 offset:9216
    ds_read_b64 v[112:113], v11 offset:9216
    s_cbranch_vccnz L_fretry2
    s_waitcnt lgkmcnt(3)
    v_mfma_f32_16x16x32_bf16 v[28:31], v[90:93], v[100:103], v[28:31]
    v_mfma_f32_16x16x32_bf16 v[32:35], v[88:91], v[100:103], v[32:35]
    v_add_f32 v15, v15, v105
L_fnext2:
L_fchk3:
    s_waitcnt lgkmcnt(2)
    v_cmp_ne_u32 vcc, s80, v114
    ds_read_b32 v106, v5 offset:6800
    ds_read_b128 v[100:103], v18 offset:12288
    ds_read_b64 v[104:105], v11 offset:12288
    s_cbranch_vccnz L_fretry3
    s_waitcnt lgkmcnt(3)
    v_mfma_f32_16x16x32_bf16 v[28:31], v[90:93], v[108:111], v[28:31]
    v_mfma_f32_16x16x32_bf16 v[32:35], v[88:91], v[108:111], v[32:35]
    v_add_f32 v15, v15, v113
L_fnext3:
L_fchk4:
    s_waitcnt lgkmcnt(2)
    v_cmp_ne_u32 vcc, s80, v106
    ds_read_b32 v114, v5 offset:6804
    ds_read_b128 v[108:111], v18 offset:15360
    ds_read_b64 v[112:113], v11 offset:15360
    s_cbranch_vccnz L_fretry4
    s_waitcnt lgkmcnt(3)
    v_mfma_f32_16x16x32_bf16 v[28:31], v[90:93], v[100:103], v[28:31]
    v_mfma_f32_16x16x32_bf16 v[32:35], v[88:91], v[100:103], v[32:35]
    v_add_f32 v15, v15, v105
L_fnext4:
L_fchk5:
    s_waitcnt lgkmcnt(2)
    v_cmp_ne_u32 vcc, s80, v114
    ds_read_b32 v106, v5 offset:6808
    ds_read_b128 v[100:103], v18 offset:18432
    ds_read_b64 v[104:105], v11 offset:18432
    s_cbranch_vccnz L_fretry5
    s_waitcnt lgkmcnt(3)
    v_mfma_f32_16x16x32_bf16 v[28:31], v[90:93], v[108:111], v[28:31]
    v_mfma_f32_16x16x32_bf16 v[32:35], v[88:91], v[108:111], v[32:35]
    v_add_f32 v15, v15, v113
L_fnext5:
L_fchk6:
    s_waitcnt lgkmcnt(2)
    v_cmp_ne_u32 vcc, s80, v106
    ds_read_b32 v114, v5 offset:6812
    ds_read_b128 v[108:111], v18 offset:21504
    ds_read_b64 v[112:113], v11 offset:21504
    s_cbranch_vccnz L_fretry6
    s_waitcnt lgkmcnt(3)
    v_mfma_f32_16x16x32_bf16 v[28:31], v[90:93], v[100:103], v[28:31]
    v_mfma_f32_16x16x32_bf16 v[32:35], v[88:91], v[100:103], v[32:35]
    v_add_f32 v15, v15, v105
L_fnext6:
L_fchk7:
    s_waitcnt lgkmcnt(2)
    v_cmp_ne_u32 vcc, s80, v114
    s_cbranch_vccnz L_fretry7
    s_waitcnt lgkmcnt(0)
    v_mfma_f32_16x16x32_bf16 v[28:31], v[90:93], v[108:111], v[28:31]
    v_mfma_f32_16x16x32_bf16 v[32:35], v[88:91], v[108:111], v[32:35]
    v_add_f32 v15, v15, v113
L_fnext7:
    v_mov_b32 v6, v15
    s_nop 1
    v_permlane32_swap_b32 v15, v6
    v_add_f32 v15, v15, v6
    v_mov_b32 v6, v15
    v_cvt_pk_bf16_f32 v44, v28, v29
    v_cvt_pk_bf16_f32 v45, v30, v31
    v_cvt_pk_bf16_f32 v46, v32, v33
    v_cvt_pk_bf16_f32 v47, v34, v35
    ds_write_b128 v13, v[44:47] offset:3328
    ds_write_b32 v17, v16 offset:6720
    v_permlane16_swap_b32 v15, v6
    v_add_f32 v15, v15, v6
L_x21:
    ds_read_b128 v[36:39], v5 offset:6720
    ds_read_b128 v[52:55], v4 offset:3328
    ds_read_b128 v[56:59], v4 offset:4352
    ds_read_b128 v[60:63], v4 offset:5376
    s_add_u32 s82, s82, 1
    s_cmp_gt_u32 s82, 4194304
    s_cbranch_scc1 L_end
    v_log_f32 v8, v15
    v_rcp_f32 v7, v15
    s_waitcnt lgkmcnt(3)
    v_min3_u32 v36, v36, v37, v38
    v_cmp_eq_u32 vcc, 0, v36
    s_waitcnt lgkmcnt(2)
    v_mfma_f32_16x16x32_bf16 v[28:31], v[64:67], v[52:55], 0
    v_mfma_f32_16x16x32_bf16 v[32:35], v[76:79], v[52:55], 0
    s_cbranch_vccnz L_x21
    s_waitcnt lgkmcnt(1)
    v_mfma_f32_16x16x32_bf16 v[28:31], v[68:71], v[56:59], v[28:31]
    v_add_f32 v8, v14, v8
    s_waitcnt lgkmcnt(0)
    v_mfma_f32_16x16x32_bf16 v[28:31], v[72:75], v[60:63], v[28:31]
    v_max_f32 v22, 0xff7fffff, v8
    v_max_f32 v26, 0xff7fffff, v8
    v_mfma_f32_16x16x32_bf16 v[32:35], v[80:83], v[56:59], v[32:35]
    v_xor_b32 v9, s79, v22
    v_mfma_f32_16x16x32_bf16 v[32:35], v[84:87], v[60:63], v[32:35]
    s_nop 2
    v_mul_f32 v28, v28, v7
    v_mul_f32 v29, v29, v7
    v_mul_f32 v30, v30, v7
    v_mul_f32 v31, v31, v7
    v_cvt_pk_bf16_f32 v20, v28, v29
    v_cvt_pk_bf16_f32 v21, v30, v31
    v_bitop3_b32 v23, v20, v21, v9 bitop3:0x96
    buffer_store_dwordx4 v[20:23], v50, s[56:59], s68 offen sc1
    v_mul_f32 v32, v32, v7
    v_mul_f32 v33, v33, v7
    v_mul_f32 v34, v34, v7
    v_mul_f32 v35, v35, v7
    v_cvt_pk_bf16_f32 v24, v32, v33
    v_cvt_pk_bf16_f32 v25, v34, v35
    v_bitop3_b32 v27, v24, v25, v9 bitop3:0x96
    buffer_store_dwordx4 v[24:27], v50, s[56:59], s69 offen sc1
    s_waitcnt vmcnt(0)
    ds_write_b32 v17, v16 offset:6736
    s_branch L_fin
L_pad16:
    s_branch L_padret
L_fretry0:
    v_cmp_gt_u32 vcc, 2, v106
    ds_read_b32 v106, v5 offset:6784
    ds_read_b128 v[100:103], v18 offset:0
    ds_read_b64 v[104:105], v11 offset:0
    s_add_u32 s82, s82, 1
    s_cmp_gt_u32 s82, 4194304
    s_cbranch_scc1 L_end
    s_cbranch_vccnz L_fchk0
    s_mov_b32 s81, 0
    s_waitcnt lgkmcnt(0)
    s_branch L_fspec0
L_fretry1:
    v_cmp_gt_u32 vcc, 2, v114
    ds_read_b32 v114, v5 offset:6788
    ds_read_b128 v[108:111], v18 offset:3072
    ds_read_b64 v[112:113], v11 offset:3072
    s_add_u32 s82, s82, 1
    s_cmp_gt_u32 s82, 4194304
    s_cbranch_scc1 L_end
    s_cbranch_vccnz L_fchk1
    s_mov_b32 s81, 1
    s_waitcnt lgkmcnt(0)
    v_mov_b32 v52, v108
    v_mov_b32 v53, v109
    v_mov_b32 v54, v110
    v_mov_b32 v55, v111
    v_mov_b32 v56, v112
    v_mov_b32 v57, v113
    s_branch L_fspec
L_fretry2:
    v_cmp_gt_u32 vcc, 2, v106
    ds_read_b32 v106, v5 offset:6792
    ds_read_b128 v[100:103], v18 offset:6144
    ds_read_b64 v[104:105], v11 offset:6144
    s_add_u32 s82, s82, 1
    s_cmp_gt_u32 s82, 4194304
    s_cbranch_scc1 L_end
    s_cbranch_vccnz L_fchk2
    s_mov_b32 s81, 2
    s_waitcnt lgkmcnt(0)
    s_branch L_fspec0
L_fretry3:
    v_cmp_gt_u32 vcc, 2, v114
    ds_read_b32 v114, v5 offset:6796
    ds_read_b128 v[108:111], v18 offset:9216
    ds_read_b64 v[112:113], v11 offset:9216
    s_add_u32 s82, s82, 1
    s_cmp_gt_u32 s82, 4194304
    s_cbranch_scc1 L_end
    s_cbranch_vccnz L_fchk3
    s_mov_b32 s81, 3
    s_waitcnt lgkmcnt(0)
    v_mov_b32 v52, v108
    v_mov_b32 v53, v109
    v_mov_b32 v54, v110
    v_mov_b32 v55, v111
    v_mov_b32 v56, v112
    v_mov_b32 v57, v113
    s_branch L_fspec
L_fretry4:
    v_cmp_gt_u32 vcc, 2, v106
    ds_read_b32 v106, v5 offset:6800
    ds_read_b128 v[100:103], v18 offset:12288
    ds_read_b64 v[104:105], v11 offset:12288
    s_add_u32 s82, s82, 1
    s_cmp_gt_u32 s82, 4194304
    s_cbranch_scc1 L_end
    s_cbranch_vccnz L_fchk4
    s_mov_b32 s81, 4
    s_waitcnt lgkmcnt(0)
    s_branch L_fspec0
L_fretry5:
    v_cmp_gt_u32 vcc, 2, v114
    ds_read_b32 v114, v5 offset:6804
    ds_read_b128 v[108:111], v18 offset:15360
    ds_read_b64 v[112:113], v11 offset:15360
    s_add_u32 s82, s82, 1
    s_cmp_gt_u32 s82, 4194304
    s_cbranch_scc1 L_end
    s_cbranch_vccnz L_fchk5
    s_mov_b32 s81, 5
    s_waitcnt lgkmcnt(0)
    v_mov_b32 v52, v108
    v_mov_b32 v53, v109
    v_mov_b32 v54, v110
    v_mov_b32 v55, v111
    v_mov_b32 v56, v112
    v_mov_b32 v57, v113
    s_branch L_fspec
L_fretry6:
    v_cmp_gt_u32 vcc, 2, v106
    ds_read_b32 v106, v5 offset:6808
    ds_read_b128 v[100:103], v18 offset:18432
    ds_read_b64 v[104:105], v11 offset:18432
    s_add_u32 s82, s82, 1
    s_cmp_gt_u32 s82, 4194304
    s_cbranch_scc1 L_end
    s_cbranch_vccnz L_fchk6
    s_mov_b32 s81, 6
    s_waitcnt lgkmcnt(0)
    s_branch L_fspec0
L_fretry7:
    v_cmp_gt_u32 vcc, 2, v114
    ds_read_b32 v114, v5 offset:6812
    ds_read_b128 v[108:111], v18 offset:21504
    ds_read_b64 v[112:113], v11 offset:21504
    s_add_u32 s82, s82, 1
    s_cmp_gt_u32 s82, 4194304
    s_cbranch_scc1 L_end
    s_cbranch_vccnz L_fchk7
    s_mov_b32 s81, 7
    s_waitcnt lgkmcnt(0)
    v_mov_b32 v52, v108
    v_mov_b32 v53, v109
    v_mov_b32 v54, v110
    v_mov_b32 v55, v111
    v_mov_b32 v56, v112
    v_mov_b32 v57, v113
    s_branch L_fspec
L_fspec0:
    v_mov_b32 v52, v100
    v_mov_b32 v53, v101
    v_mov_b32 v54, v102
    v_mov_b32 v55, v103
    v_mov_b32 v56, v104
    v_mov_b32 v57, v105
L_fspec:
    s_mov_b32 s80, 7
    s_nop 1
    v_mfma_f32_16x16x32_bf16 v[36:39], v[90:93], v[52:55], 0
    v_mfma_f32_16x16x32_bf16 v[40:43], v[88:91], v[52:55], 0
    v_max_f32 v6, v14, v56
    v_sub_f32 v14, v14, v6
    v_sub_f32 v56, v56, v6
    v_exp_f32 v8, v14
    v_exp_f32 v56, v56
    v_mov_b32 v14, v6
    v_mul_f32 v15, v15, v8
    v_fmac_f32 v15, v56, v57
    v_mul_f32 v28, v28, v8
    v_mul_f32 v29, v29, v8
    v_mul_f32 v30, v30, v8
    v_mul_f32 v31, v31, v8
    v_mul_f32 v32, v32, v8
    v_mul_f32 v33, v33, v8
    v_mul_f32 v34, v34, v8
    v_mul_f32 v35, v35, v8
    v_fmac_f32 v28, v36, v56
    v_fmac_f32 v29, v37, v56
    v_fmac_f32 v30, v38, v56
    v_fmac_f32 v31, v39, v56
    v_fmac_f32 v32, v40, v56
    v_fmac_f32 v33, v41, v56
    v_fmac_f32 v34, v42, v56
    v_fmac_f32 v35, v43, v56
    s_cmp_eq_u32 s81, 0
    s_cbranch_scc1 L_fnext0
    s_cmp_eq_u32 s81, 1
    s_cbranch_scc1 L_fnext1
    s_cmp_eq_u32 s81, 2
    s_cbranch_scc1 L_fnext2
    s_cmp_eq_u32 s81, 3
    s_cbranch_scc1 L_fnext3
    s_cmp_eq_u32 s81, 4
    s_cbranch_scc1 L_fnext4
    s_cmp_eq_u32 s81, 5
    s_cbranch_scc1 L_fnext5
    s_cmp_eq_u32 s81, 6
    s_cbranch_scc1 L_fnext6
    s_branch L_fnext7
L_fin:
L_end:
    s_endpgm

L_pad18:
L_pad19:
    s_branch L_padret
.section .rodata,"a"
.p2align 6
.amdhsa_kernel standalone__detection_seg_dino__vision_kernel
  .amdhsa_next_free_vgpr 152
  .amdhsa_next_free_sgpr 102
  .amdhsa_accum_offset 152
  .amdhsa_group_segment_fixed_size 0
  .amdhsa_kernarg_size 80
  .amdhsa_user_sgpr_count 2
  .amdhsa_user_sgpr_kernarg_segment_ptr 1
  .amdhsa_system_sgpr_workgroup_id_x 1
  .amdhsa_float_denorm_mode_32 3
.end_amdhsa_kernel
```
